```python
import torch

def _softmax(x, axis=-1):
    return torch.softmax(x, dim=axis)
def _gelu(x):
    return torch.nn.functional.gelu(x, approximate="tanh")
def _silu(x):
    return torch.nn.functional.silu(x)
def _sigmoid(x):
    return torch.sigmoid(x)
def _layernorm(x, axis=-1, eps=1e-5):
    m = x.mean(dim=axis, keepdim=True)
    v = x.var(dim=axis, keepdim=True, unbiased=False)
    return (x - m) / torch.sqrt(v + eps)
def _scatter_add(tgt, idx, src, axis=0):
    return tgt.clone().index_add_(axis, idx, src)
def _segment_sum(src, seg, n):
    out = torch.zeros((n,) + src.shape[1:], dtype=src.dtype)
    return out.index_add_(0, seg, src)
def _pad(x, pw):
    flat = tuple(v for pair in reversed(pw) for v in pair)
    return torch.nn.functional.pad(x, flat)

kernel_name = 'recurrent_scan__compressed_kv_cla__glu_gated_geglu__decode'

def setup_inputs():

    _w = (lambda a: (lambda t: t.to(torch.bfloat16) if t.is_floating_point() else t)(torch.as_tensor(a)))
    def _A_setup():
        B, H, Sq, Sk, D, M = 4, 32, 1, 4096, 128, 576
        Dc = 4 * D
        return {
            "x": _w((lambda *s: torch.randn(*s, dtype=torch.bfloat16) * 0.05)(B, Sq, M)),
            "c_kv": _w((lambda *s: torch.randn(*s, dtype=torch.bfloat16) * 1.6)(B, Sk, Dc)),
            "w_q": _w((lambda *s: torch.randn(*s, dtype=torch.bfloat16) * 1.6)(M, H, D) * (M ** -0.5)),
            "w_uk": _w((lambda *s: torch.randn(*s, dtype=torch.bfloat16) * 1.6)(Dc, H, D) * (Dc ** -0.5)),
            "w_uv": _w((lambda *s: torch.randn(*s, dtype=torch.bfloat16) * 1.6)(Dc, H, D) * (Dc ** -0.5)),
            "w_o": _w((lambda *s: torch.randn(*s, dtype=torch.bfloat16) * 1.6)(H, D, M) * ((H * D) ** -0.5)),
        }
    _A_in = _A_setup()

    def _B_setup():
        B, S, Dm, Df = 4, 1, 576, 4608
        return {
            "x": _w((lambda *s: torch.randn(*s, dtype=torch.bfloat16) * 0.05)(B, S, Dm)),
            "w_gate": _w((lambda *s: torch.randn(*s, dtype=torch.bfloat16) * 0.2)(Dm, Df) * (Dm ** -0.5)),
            "w_up": _w((lambda *s: torch.randn(*s, dtype=torch.bfloat16) * 0.2)(Dm, Df) * (Dm ** -0.5)),
            "w_down": _w((lambda *s: torch.randn(*s, dtype=torch.bfloat16) * 0.2)(Df, Dm) * (Df ** -0.5)),
        }
    _B_in = _B_setup()

    return {
        "A_x": _A_in["x"],
        "A_c_kv": _A_in["c_kv"],
        "A_w_q": _A_in["w_q"],
        "A_w_uk": _A_in["w_uk"],
        "A_w_uv": _A_in["w_uv"],
        "A_w_o": _A_in["w_o"],
        "B_x": _B_in["x"],
        "B_w_gate": _B_in["w_gate"],
        "B_w_up": _B_in["w_up"],
        "B_w_down": _B_in["w_down"],
    }

def reference(A_x, A_c_kv, A_w_q, A_w_uk, A_w_uv, A_w_o, B_x, B_w_gate, B_w_up, B_w_down):
    def _A_ref(x, c_kv, w_q, w_uk, w_uv, w_o):
        B, Sq, M = x.shape[0], x.shape[1], x.shape[2]
        Sk = c_kv.shape[1]
        H, D = w_q.shape[1], w_q.shape[2]
        q = torch.einsum("bqm,mhd->bhqd", x, w_q)
        k = torch.einsum("bkc,chd->bhkd", c_kv, w_uk)
        v = torch.einsum("bkc,chd->bhkd", c_kv, w_uv)
        scores = torch.einsum("bhqd,bhkd->bhqk", q, k) * (D ** -0.5)
        off = Sk - Sq
        qi = torch.arange(Sq)[:, None]
        kj = torch.arange(Sk)[None, :]
        cmask = kj <= (qi + off)
        scores = torch.where(cmask[None, None], scores, -1e9)
        p = _softmax(scores, axis=-1)
        ctx = torch.einsum("bhqk,bhkd->bhqd", p, v)
        return torch.einsum("bhqd,hdm->bqm", ctx, w_o)

    def _B_ref(x, w_gate, w_up, w_down):
        g = torch.einsum("bsd,df->bsf", x, w_gate)
        u = torch.einsum("bsd,df->bsf", x, w_up)
        h = _gelu(g) * u
        return torch.einsum("bsf,fd->bsd", h, w_down)

    x = A_x
    xn = _layernorm(x, axis=-1)
    s = _A_ref(xn, A_c_kv, A_w_q, A_w_uk, A_w_uv, A_w_o)
    g = _silu(_B_ref(xn, B_w_gate, B_w_up, B_w_down))
    return x + s * g
```

```asm
; @launch grid=(256,1,1) block=(512,1,1) lds=163840
.amdgcn_target "amdgcn-amd-amdhsa--gfx950"
.text
.globl recurrent_scan__compressed_kv_cla__glu_gated_geglu__decode_kernel
.p2align 8
.type recurrent_scan__compressed_kv_cla__glu_gated_geglu__decode_kernel,@function
recurrent_scan__compressed_kv_cla__glu_gated_geglu__decode_kernel:
    s_load_dwordx2 s[60:61], s[0:1], 24
    s_lshr_b32 s3, s2, 7
    s_cbranch_scc1 L_nq
    v_lshrrev_b32 v3, 6, v0
    v_and_b32 v1, 63, v0
    v_lshlrev_b32 v9, 4, v1
    v_lshl_add_u32 v2, v3, 13, v9
    s_and_b32 s45, s2, 7
    s_lshl_b32 s68, s45, 10
    s_lshr_b32 s46, s2, 3
    s_lshl_b32 s69, s46, 18
    s_add_u32 s68, s68, s69
    v_add_u32 v2, s68, v2
    s_waitcnt lgkmcnt(0)
    global_load_dwordx4 v[248:251], v2, s[60:61]
    v_add_u32 v2, 0x10000, v2
    global_load_dwordx4 v[248:251], v2, s[60:61]
    v_add_u32 v2, 0x10000, v2
    global_load_dwordx4 v[248:251], v2, s[60:61]
    v_add_u32 v2, 0x10000, v2
    global_load_dwordx4 v[248:251], v2, s[60:61]
    s_getpc_b64 s[66:67]
L_pc:
    v_readfirstlane_b32 s44, v3
    v_lshlrev_b32 v2, 7, v0
    v_cmp_gt_u32 vcc, L_exit-L_pc, v2
    s_nop 0
    s_and_saveexec_b64 s[68:69], vcc
    s_cbranch_execz L_att
    global_load_dword v247, v2, s[66:67]
    s_branch L_att
L_nq:
    s_load_dwordx2 s[56:57], s[0:1], 16
    s_load_dwordx2 s[52:53], s[0:1], 0
    v_lshrrev_b32 v2, 6, v0
    s_and_b32 s45, s2, 7
    s_mov_b32 s59, 0x20000
    v_readfirstlane_b32 s44, v2
    s_cmp_ge_u32 s2, 256
    s_cbranch_scc1 L_exit
    s_movk_i32 s70, 128
    v_bfe_u32 v2, v0, 3, 4
    v_lshrrev_b32 v3, 8, v0
    v_lshl_add_u32 v3, v3, 4, v2
    v_lshrrev_b32 v11, 1, v2
    v_and_b32 v11, 4, v11
    v_and_or_b32 v11, v2, 2, v11
    v_xor_b32 v11, v11, v0
    v_and_b32 v11, 7, v11
    v_lshlrev_b32 v11, 4, v11
    v_and_or_b32 v12, v0, s70, v11
    v_lshl_add_u32 v12, v3, 13, v12
    s_bfe_u32 s65, s2, 0x20005
    s_bfe_u32 s64, s2, 0x20003
    s_lshl2_add_u32 s47, s45, s65
    s_mul_i32 s72, s64, 1179648
    s_lshl_b32 s73, s47, 8
    s_add_u32 s72, s72, s73
    s_mov_b32 s58, 4718592
    s_and_b32 s67, s44, 1
    s_bfe_u32 s69, s44, 0x10001
    s_and_b32 s71, s44, 4
    s_lshl1_add_u32 s71, s67, s71
    s_add_u32 s71, s71, s69
    s_lshl_b32 s71, s71, 10
    s_add_u32 m0, s71, 126976
    v_and_b32 v1, 63, v0
    s_mul_i32 s66, s44, 1152
    v_lshl_add_u32 v13, v1, 3, s66
    v_lshl_add_u32 v14, v1, 1, s66
    s_lshr_b32 s70, s44, 2
    s_waitcnt lgkmcnt(0)
    s_cbranch_scc1 L_nq_nox
    global_load_dwordx2 v[20:21], v13, s[52:53]
    global_load_dwordx2 v[22:23], v13, s[52:53] offset:512
    global_load_ushort v24, v14, s[52:53] offset:1024
L_nq_nox:
    buffer_load_dwordx4 v12, s[56:59], s72 offen nt lds
    s_add_u32 s72, s72, 262144
    s_add_u32 m0, s71, 135168
    s_nop 0
    buffer_load_dwordx4 v12, s[56:59], s72 offen nt lds
    s_add_u32 s72, s72, 262144
    s_add_u32 m0, s71, 143360
    s_nop 0
    buffer_load_dwordx4 v12, s[56:59], s72 offen nt lds
    s_add_u32 s72, s72, 262144
    s_add_u32 m0, s71, 151552
    s_nop 0
    buffer_load_dwordx4 v12, s[56:59], s72 offen nt lds
    s_add_u32 s72, s72, 262144
    s_add_u32 m0, s71, 159744
    s_cmp_lg_u32 s70, 0
    s_cbranch_scc1 L_nq_d4
    buffer_load_dwordx4 v12, s[56:59], s72 offen nt lds
L_nq_d4:
    s_load_dwordx2 s[48:49], s[0:1], 96
    s_load_dwordx16 s[16:31], s[0:1], 0
    s_load_dwordx8 s[32:39], s[0:1], 64
    s_mov_b32 s50, 0x10000000
    s_mov_b32 s51, 0x20000
    s_mov_b32 s55, 0x20000
    s_lshr_b32 s46, s2, 3
    v_lshlrev_b32 v9, 4, v1
    s_mov_b32 s62, 4194304
    s_mov_b32 s63, 0x20000
    v_lshrrev_b32 v2, 3, v1
    v_and_b32 v3, 7, v1
    v_lshrrev_b32 v4, 4, v1
    v_bfe_u32 v5, v1, 2, 2
    v_and_b32 v6, 3, v1
    v_lshlrev_b32 v7, 4, v0
    v_mov_b32 v8, 0
    v_lshl_add_u32 v12, v2, 13, v11
    s_lshl_b32 s74, s69, 7
    s_add_u32 s73, s73, s74
    s_mov_b32 s54, 4608
    v_lshlrev_b32 v10, 3, v1
    v_lshlrev_b32 v19, 1, v1
    s_waitcnt lgkmcnt(0)
    s_load_dword s42, s[48:49], 0
    s_lshr_b32 s68, s44, 1
    s_cmp_ge_u32 s64, 2
    s_cbranch_scc1 L_nq_fs
    s_lshl_b32 s71, s70, 3
    s_add_u32 s71, s71, s67
    s_lshl_b32 s72, s64, 5
    s_add_u32 s72, s72, s71
    s_lshl_b32 s72, s72, 16
    s_add_u32 s72, s72, s73
    s_lshl_b32 s71, s71, 1
    s_add_u32 s71, s71, s69
    s_lshl_b32 s71, s71, 10
    s_add_u32 s71, s71, 16384
    s_cmp_eq_u32 s70, 0
    s_cbranch_scc1 L_nq_ln
    v_mov_b32 v24, -1
    v_mov_b32 v25, -1
    v_mov_b32 v26, -1
    v_mov_b32 v27, -1
    s_lshl_b32 s75, s44, 12
    s_lshl_b32 s74, s47, 14
    s_add_u32 s74, s74, s75
    s_add_u32 s74, s74, 1294336
    buffer_store_dwordx4 v[24:27], v9, s[48:51], s74 offen sc1
    buffer_store_dwordx4 v[24:27], v9, s[48:51], s74 offen offset:2048 sc1
    s_mov_b64 exec, 0xff
    buffer_store_dwordx4 v[24:27], v9, s[48:51], s74 offen offset:1024 sc1
    buffer_store_dwordx4 v[24:27], v9, s[48:51], s74 offen offset:3072 sc1
    s_lshl_b32 s75, s44, 15
    s_lshl_b32 s74, s47, 10
    s_add_u32 s74, s74, s75
    s_lshl_b32 s75, s64, 9
    s_add_u32 s74, s74, s75
    s_add_u32 s74, s74, 393216
    s_mov_b32 exec_lo, -1
    buffer_store_dwordx4 v[24:27], v9, s[48:51], s74 offen sc1
    s_mov_b64 exec, -1
    s_branch L_nq_noln
L_nq_fs:
    s_cmp_lg_u32 s46, 30
    s_cbranch_scc1 L_nq_fs2
    s_cmp_eq_u32 s70, 0
    s_cbranch_scc1 L_nq_ln
    v_mov_b32 v24, -1
    v_mov_b32 v25, -1
    v_mov_b32 v26, -1
    v_mov_b32 v27, -1
    s_lshl_b32 s75, s44, 12
    s_lshl_b32 s74, s47, 14
    s_add_u32 s74, s74, s75
    s_add_u32 s74, s74, 1294336
    buffer_store_dwordx4 v[24:27], v9, s[48:51], s74 offen sc1
    buffer_store_dwordx4 v[24:27], v9, s[48:51], s74 offen offset:2048 sc1
    s_mov_b64 exec, 0xff
    buffer_store_dwordx4 v[24:27], v9, s[48:51], s74 offen offset:1024 sc1
    buffer_store_dwordx4 v[24:27], v9, s[48:51], s74 offen offset:3072 sc1
    s_mov_b64 exec, -1
    s_branch L_nq_noln
L_nq_fs2:
    s_lshl_b32 s71, s65, 1
    s_add_u32 s71, s71, s64
    s_lshr_b32 s72, s64, 1
    s_cmp_eq_u32 s65, 3
    s_cselect_b32 s72, s72, 2
    s_sub_u32 s71, s71, s72
    s_mul_i32 s76, s45, 9
    s_add_u32 s76, s76, s71
    s_cmp_eq_u32 s69, 0
    s_cselect_b32 s60, s30, s32
    s_cselect_b32 s61, s31, s33
    s_mov_b32 s62, 5308416
    s_lshl_b32 s72, s67, 1
    s_lshl_b32 s71, s69, 2
    s_or_b32 s72, s72, s71
    v_bfe_u32 v14, v2, 1, 1
    v_or_b32 v14, s72, v14
    v_xor_b32 v14, v14, v3
    v_lshlrev_b32 v14, 4, v14
    v_mul_u32_u24 v12, 9216, v2
    v_add_u32 v12, v12, v14
    s_lshl_b32 s71, s70, 1
    s_add_u32 s71, s71, s67
    s_mul_i32 s72, s71, 73728
    s_lshl_b32 s74, s76, 7
    s_add_u32 s72, s72, s74
    s_lshl_b32 s71, s71, 1
    s_add_u32 s71, s71, s69
    s_lshl_b32 s71, s71, 10
    s_add_u32 s71, s71, 16384
    s_cmp_lg_u32 s70, 0
    s_cbranch_scc1 L_nq_noln
L_nq_ln:
    s_waitcnt vmcnt(5)
    v_lshlrev_b32 v56, 16, v20
    v_and_b32 v57, 0xffff0000, v20
    v_lshlrev_b32 v58, 16, v21
    v_and_b32 v59, 0xffff0000, v21
    v_lshlrev_b32 v60, 16, v22
    v_and_b32 v61, 0xffff0000, v22
    v_lshlrev_b32 v62, 16, v23
    v_and_b32 v63, 0xffff0000, v23
    v_lshlrev_b32 v64, 16, v24
    v_add_f32 v25, v56, v57
    v_add_f32 v26, v58, v59
    v_add_f32 v27, v60, v61
    v_add_f32 v28, v62, v63
    v_add_f32 v25, v25, v26
    v_add_f32 v27, v27, v28
    v_add_f32 v25, v25, v64
    v_add_f32 v25, v25, v27
    s_nop 1
    v_add_f32_dpp v25, v25, v25 row_ror:8 row_mask:0xf bank_mask:0xf
    s_nop 1
    v_add_f32_dpp v25, v25, v25 row_ror:4 row_mask:0xf bank_mask:0xf
    s_nop 1
    v_add_f32_dpp v25, v25, v25 row_ror:2 row_mask:0xf bank_mask:0xf
    s_nop 1
    v_add_f32_dpp v25, v25, v25 row_ror:1 row_mask:0xf bank_mask:0xf
    s_nop 1
    v_add_f32_dpp v25, v25, v25 row_bcast:15 row_mask:0xa bank_mask:0xf
    s_nop 1
    v_add_f32_dpp v25, v25, v25 row_bcast:31 row_mask:0xc bank_mask:0xf
    s_nop 0
    v_readlane_b32 s74, v25, 63
    v_mov_b32 v26, 0x3ae38e39
    s_nop 0
    v_mul_f32 v26, s74, v26
    v_sub_f32 v27, v56, v26
    v_mul_f32 v25, v27, v27
    v_sub_f32 v27, v57, v26
    v_fmac_f32 v25, v27, v27
    v_sub_f32 v27, v58, v26
    v_fmac_f32 v25, v27, v27
    v_sub_f32 v27, v59, v26
    v_fmac_f32 v25, v27, v27
    v_sub_f32 v27, v60, v26
    v_fmac_f32 v25, v27, v27
    v_sub_f32 v27, v61, v26
    v_fmac_f32 v25, v27, v27
    v_sub_f32 v27, v62, v26
    v_fmac_f32 v25, v27, v27
    v_sub_f32 v27, v63, v26
    v_fmac_f32 v25, v27, v27
    v_sub_f32 v27, v64, v26
    v_fmac_f32 v25, v27, v27
    v_cvt_pk_bf16_f32 v26, v26, v26
    v_lshlrev_b32 v26, 16, v26
    v_sub_f32 v56, v56, v26
    v_sub_f32 v57, v57, v26
    v_sub_f32 v58, v58, v26
    v_sub_f32 v59, v59, v26
    v_sub_f32 v60, v60, v26
    v_sub_f32 v61, v61, v26
    v_sub_f32 v62, v62, v26
    v_sub_f32 v63, v63, v26
    v_sub_f32 v64, v64, v26
    v_add_f32_dpp v25, v25, v25 row_ror:8 row_mask:0xf bank_mask:0xf
    s_nop 1
    v_add_f32_dpp v25, v25, v25 row_ror:4 row_mask:0xf bank_mask:0xf
    s_nop 1
    v_add_f32_dpp v25, v25, v25 row_ror:2 row_mask:0xf bank_mask:0xf
    s_nop 1
    v_add_f32_dpp v25, v25, v25 row_ror:1 row_mask:0xf bank_mask:0xf
    s_nop 1
    v_add_f32_dpp v25, v25, v25 row_bcast:15 row_mask:0xa bank_mask:0xf
    s_nop 1
    v_add_f32_dpp v25, v25, v25 row_bcast:31 row_mask:0xc bank_mask:0xf
    s_nop 0
    v_readlane_b32 s74, v25, 63
    v_mov_b32 v27, 0x3ae38e39
    s_nop 0
    v_mul_f32 v27, s74, v27
    v_cvt_pk_bf16_f32 v27, v27, v27
    v_lshlrev_b32 v27, 16, v27
    v_add_f32 v27, 0x3727c5ac, v27
    v_cvt_pk_bf16_f32 v27, v27, v27
    v_lshlrev_b32 v27, 16, v27
    v_sqrt_f32 v27, v27
    s_nop 0
    v_cvt_pk_bf16_f32 v27, v27, v27
    v_lshlrev_b32 v27, 16, v27
    v_rcp_f32 v27, v27
    v_cvt_pk_bf16_f32 v20, v56, v57
    v_cvt_pk_bf16_f32 v21, v58, v59
    v_cvt_pk_bf16_f32 v22, v60, v61
    v_cvt_pk_bf16_f32 v23, v62, v63
    v_cvt_pk_bf16_f32 v24, v64, v64
    v_lshlrev_b32 v56, 16, v20
    v_and_b32 v57, 0xffff0000, v20
    v_lshlrev_b32 v58, 16, v21
    v_and_b32 v59, 0xffff0000, v21
    v_lshlrev_b32 v60, 16, v22
    v_and_b32 v61, 0xffff0000, v22
    v_lshlrev_b32 v62, 16, v23
    v_and_b32 v63, 0xffff0000, v23
    v_lshlrev_b32 v64, 16, v24
    v_mul_f32 v56, v56, v27
    v_mul_f32 v57, v57, v27
    v_mul_f32 v58, v58, v27
    v_mul_f32 v59, v59, v27
    v_mul_f32 v60, v60, v27
    v_mul_f32 v61, v61, v27
    v_mul_f32 v62, v62, v27
    v_mul_f32 v63, v63, v27
    v_mul_f32 v64, v64, v27
    v_cvt_pk_bf16_f32 v20, v56, v57
    v_cvt_pk_bf16_f32 v21, v58, v59
    v_cvt_pk_bf16_f32 v22, v60, v61
    v_cvt_pk_bf16_f32 v23, v62, v63
    v_cvt_pk_bf16_f32 v24, v64, v64
    s_mul_i32 s74, s44, 1216
    v_add_u32 v10, s74, v10
    v_add_u32 v19, s74, v19
    ds_write_b64 v10, v[20:21] offset:0
    ds_write_b64 v10, v[22:23] offset:512
    ds_write_b16 v19, v24 offset:1024
L_nq_noln:
    s_and_b32 s74, s44, 3
    s_lshl_b32 s74, s74, 1
    v_lshrrev_b32 v13, 1, v6
    v_or_b32 v13, s74, v13
    v_and_b32 v14, 2, v5
    v_xor_b32 v13, v13, v14
    v_and_b32 v14, 1, v4
    v_lshlrev_b32 v15, 2, v14
    v_xor_b32 v13, v13, v15
    v_lshlrev_b32 v13, 4, v13
    v_lshl_add_u32 v13, v5, 7, v13
    v_and_b32 v15, 1, v6
    v_lshl_add_u32 v13, v15, 3, v13
    s_lshl_b32 s74, s70, 10
    s_add_u32 s74, s74, 16384
    v_add_u32 v15, s74, v13
    v_lshl_add_u32 v16, v4, 11, v15
    v_mul_u32_u24 v18, 1216, v6
    v_lshl_add_u32 v18, v4, 4, v18
    s_mov_b32 s78, 0x000f000f
    s_mov_b32 s79, 0x000f000f
    v_add_u32 v21, 110592, v16
    v_and_b32 v14, 1, v4
    v_lshl_add_u32 v17, v14, 11, v15
    v_add_u32 v17, 110592, v17
    s_mul_i32 s74, s64, 288
    v_add_u32 v19, s74, v18
    s_lshl_b32 s66, s47, 13
    s_add_u32 s66, s66, 786432
    s_lshl_b32 s75, s64, 11
    s_add_u32 s75, s75, s66
    s_lshl_b32 s77, s44, 8
    s_add_u32 s75, s75, s77
    v_lshlrev_b32 v20, 6, v6
    v_lshl_add_u32 v20, v4, 4, v20
    v_cmp_gt_u32 vcc, 2, v4
    s_cmp_lt_u32 s64, 2
    s_cbranch_scc1 L_nq_uk
    s_waitcnt vmcnt(0)
    s_branch L_nq_a
L_nq_uk:
    s_waitcnt vmcnt(5)
    s_cmp_lg_u32 s70, 0
    s_cbranch_scc1 L_nq_uk2
    s_waitcnt vmcnt(0)
L_nq_uk2:
    s_mov_b32 m0, s71
    s_add_u32 s71, s71, 4096
    buffer_load_dwordx4 v12, s[60:63], s72 offen nt lds
    s_add_u32 s72, s72, 131072
    s_mov_b32 m0, s71
    s_add_u32 s71, s71, 4096
    buffer_load_dwordx4 v12, s[60:63], s72 offen nt lds
    s_add_u32 s72, s72, 131072
    s_mov_b32 m0, s71
    s_add_u32 s71, s71, 4096
    buffer_load_dwordx4 v12, s[60:63], s72 offen nt lds
    s_add_u32 s72, s72, 131072
    s_mov_b32 m0, s71
    s_add_u32 s71, s71, 4096
    buffer_load_dwordx4 v12, s[60:63], s72 offen nt lds
    s_add_u32 s72, s72, 131072
L_nq_a:
    s_waitcnt lgkmcnt(0)
    s_barrier
    ds_read_b64_tr_b16 v[64:65], v21 offset:0
    ds_read_b64_tr_b16 v[66:67], v21 offset:512
    ds_read_b128 v[96:99], v19 offset:0
    ds_read_b64_tr_b16 v[68:69], v21 offset:8192
    ds_read_b64_tr_b16 v[70:71], v21 offset:8704
    ds_read_b128 v[100:103], v19 offset:64
    ds_read_b64_tr_b16 v[72:73], v21 offset:16384
    ds_read_b64_tr_b16 v[74:75], v21 offset:16896
    ds_read_b128 v[104:107], v19 offset:128
    ds_read_b64_tr_b16 v[76:77], v21 offset:24576
    ds_read_b64_tr_b16 v[78:79], v21 offset:25088
    ds_read_b128 v[108:111], v19 offset:192
    ds_read_b64_tr_b16 v[80:81], v17 offset:32768
    ds_read_b64_tr_b16 v[82:83], v17 offset:33280
    ds_read_b128 v[112:115], v19 offset:256
    s_add_u32 s42, s42, 1
    s_mul_i32 s43, s42, 0x9E3779B1
    s_xor_b32 s43, s43, 0x5BD1E995
    v_mov_b32 v25, s43
    v_mov_b32 v27, s43
    s_waitcnt lgkmcnt(12)
    v_mfma_f32_16x16x32_bf16 v[28:31], v[64:67], v[96:99], 0
    s_waitcnt lgkmcnt(9)
    v_mfma_f32_16x16x32_bf16 v[28:31], v[68:71], v[100:103], v[28:31]
    s_waitcnt lgkmcnt(6)
    v_mfma_f32_16x16x32_bf16 v[28:31], v[72:75], v[104:107], v[28:31]
    s_waitcnt lgkmcnt(3)
    v_mfma_f32_16x16x32_bf16 v[28:31], v[76:79], v[108:111], v[28:31]
    s_waitcnt lgkmcnt(0)
    v_cndmask_b32 v112, 0, v112, vcc
    v_cndmask_b32 v113, 0, v113, vcc
    v_cndmask_b32 v114, 0, v114, vcc
    v_cndmask_b32 v115, 0, v115, vcc
    s_nop 1
    v_mfma_f32_16x16x32_bf16 v[28:31], v[80:83], v[112:115], v[28:31]
    v_and_b32 v52, 1, v2
    v_and_b32 v53, 2, v3
    v_lshl_or_b32 v53, v52, 2, v53
    v_xor_b32 v53, v53, v4
    v_lshlrev_b32 v53, 4, v53
    v_lshl_add_u32 v53, v3, 7, v53
    v_lshl_add_u32 v52, v52, 11, v53
    s_nop 0
    v_cvt_pk_bf16_f32 v24, v28, v29
    v_cvt_pk_bf16_f32 v26, v30, v31
    s_mov_b64 exec, s[78:79]
    buffer_store_dwordx4 v[24:27], v20, s[48:51], s75 offen
    s_sub_u32 s75, s75, 524288
    s_cmp_lt_u32 s64, 2
    s_cbranch_scc1 L_nq_b
    buffer_store_dwordx4 v[24:27], v20, s[48:51], s75 offen sc1
    s_mov_b64 exec, -1
    s_barrier
    s_cmp_eq_u32 s46, 30
    s_cbranch_scc1 L_T
    s_mov_b32 s56, s18
    s_mov_b32 s57, s19
    s_lshl_b32 s74, s65, 1
    s_add_u32 s74, s74, s64
    s_sub_u32 s74, s74, 2
    s_min_u32 s74, s74, 6
    s_lshl_b32 s74, s74, 3
    s_add_u32 s74, s74, s44
    s_lshr_b32 s77, s74, 2
    s_lshl_b32 s77, s77, 15
    s_and_b32 s74, s74, 3
    s_lshl_b32 s74, s74, 10
    s_add_u32 s74, s74, s77
    s_lshl_b32 s75, s45, 21
    s_add_u32 s74, s74, s75
    s_add_u32 s74, s74, 28672
    s_add_u32 s58, s75, 2097152
    buffer_load_dwordx4 v[248:251], v9, s[56:59], s74 offen
    s_add_u32 s74, s74, 458752
    buffer_load_dwordx4 v[248:251], v9, s[56:59], s74 offen
    s_add_u32 s74, s74, 458752
    buffer_load_dwordx4 v[248:251], v9, s[56:59], s74 offen
    s_add_u32 s74, s74, 458752
    buffer_load_dwordx4 v[248:251], v9, s[56:59], s74 offen
    s_add_u32 s74, s74, 458752
    buffer_load_dwordx4 v[248:251], v9, s[56:59], s74 offen
    s_branch L_F
L_nq_b:
    s_mov_b64 exec, -1
    s_barrier
    s_add_u32 s71, s71, 16384
    s_add_u32 s72, s72, 524288
    s_mov_b32 m0, s71
    s_add_u32 s71, s71, 4096
    buffer_load_dwordx4 v12, s[60:63], s72 offen nt lds
    s_add_u32 s72, s72, 131072
    s_mov_b32 m0, s71
    s_add_u32 s71, s71, 4096
    buffer_load_dwordx4 v12, s[60:63], s72 offen nt lds
    s_add_u32 s72, s72, 131072
    s_mov_b32 m0, s71
    s_add_u32 s71, s71, 4096
    buffer_load_dwordx4 v12, s[60:63], s72 offen nt lds
    s_add_u32 s72, s72, 131072
    s_mov_b32 m0, s71
    s_add_u32 s71, s71, 4096
    buffer_load_dwordx4 v12, s[60:63], s72 offen nt lds
    s_mul_i32 s74, s68, 1088
    s_lshl_b32 s77, s67, 7
    s_add_u32 s74, s74, s77
    v_mul_u32_u24 v22, 272, v5
    v_lshl_add_u32 v22, v4, 5, v22
    v_lshl_add_u32 v22, v6, 3, v22
    v_add_u32 v22, s74, v22
    s_lshl_b32 s77, s44, 13
    s_add_u32 s77, s77, 16384
    v_add_u32 v52, s77, v52
    v_xor_b32 v53, 64, v52
    v_and_b32 v23, 15, v1
    v_mul_u32_u24 v23, 272, v23
    v_lshl_add_u32 v23, v4, 4, v23
    s_lshl_b32 s72, s47, 10
    s_lshl_b32 s74, s64, 9
    s_add_u32 s72, s72, s74
    s_lshl_b32 s74, s44, 6
    s_add_u32 s72, s72, s74
    s_add_u32 s72, s72, 524288
    v_and_b32 v21, 1, v5
    v_lshlrev_b32 v54, 15, v6
    v_lshlrev_b32 v55, 10, v1
    s_lshl_b32 s76, s45, 7
    s_lshl_b32 s74, s65, 3
    s_add_u32 s76, s76, s74
    s_lshl_b32 s74, s64, 2
    s_add_u32 s76, s76, s74
    s_add_u32 s76, s76, 655360
    v_mov_b32 v44, s43
    v_mov_b32 v45, s43
    v_mov_b32 v46, s43
    v_mov_b32 v47, s43
    v_lshl_add_u32 v54, v21, 5, v54
    v_lshl_add_u32 v54, v4, 3, v54
    s_sub_u32 s71, s66, 524288
    s_mov_b32 s77, 0
L_h1poll:
    s_cmp_lg_u32 s77, 6
    s_cbranch_scc1 L_h1ng
    s_mov_b64 exec, s[78:79]
    buffer_store_dwordx4 v[24:27], v20, s[48:51], s75 offen sc1
    s_mov_b64 exec, -1
L_h1ng:
    s_and_b32 s74, s77, 9
    s_cmp_eq_u32 s74, 9
    s_cselect_b32 s74, s71, s66
    buffer_load_dwordx4 v[48:51], v7, s[48:51], s74 offen sc1
    s_add_u32 s77, s77, 1
    s_waitcnt vmcnt(0)
    v_xor_b32 v49, s43, v49
    v_xor_b32 v51, s43, v51
    v_or_b32 v49, v49, v51
    v_cmp_ne_u32 vcc, 0, v49
    s_cmp_ge_u32 s77, 400000
    s_cbranch_scc1 L_h1done
    s_cbranch_vccnz L_h1poll
L_h1done:
    v_mov_b32 v49, v50
    ds_write_b64 v22, v[48:49] offset:5120
    s_cmp_gt_u32 s77, 6
    s_cbranch_scc1 L_h1sent
    s_mov_b64 exec, s[78:79]
    buffer_store_dwordx4 v[24:27], v20, s[48:51], s75 offen sc1
    s_mov_b64 exec, -1
L_h1sent:
L_h1np:
    v_cmp_ne_u32 vcc, 0, v21
    s_waitcnt lgkmcnt(0)
    s_barrier
    s_cmp_lg_u32 s44, 0
    s_cbranch_scc1 L_nopq
    s_mov_b64 exec, 0xffff
    buffer_store_dword v44, v55, s[48:51], s76 offen sc1
    s_mov_b64 exec, -1
L_nopq:
    ds_read_b128 v[96:99], v23 offset:5120
    ds_read_b128 v[64:67], v52 offset:0
    ds_read_b128 v[80:83], v52 offset:4096
    ds_read_b128 v[100:103], v23 offset:5184
    ds_read_b128 v[68:71], v53 offset:0
    ds_read_b128 v[84:87], v53 offset:4096
    ds_read_b128 v[104:107], v23 offset:5248
    ds_read_b128 v[72:75], v52 offset:1024
    ds_read_b128 v[88:91], v52 offset:5120
    ds_read_b128 v[108:111], v23 offset:5312
    ds_read_b128 v[76:79], v53 offset:1024
    ds_read_b128 v[92:95], v53 offset:5120
    s_mov_b32 s74, 0x3e0293ee
    s_waitcnt lgkmcnt(10)
    v_mfma_f32_16x16x32_bf16 v[28:31], v[64:67], v[96:99], 0
    s_waitcnt lgkmcnt(9)
    v_mfma_f32_16x16x32_bf16 v[56:59], v[80:83], v[96:99], 0
    s_waitcnt lgkmcnt(7)
    v_mfma_f32_16x16x32_bf16 v[28:31], v[68:71], v[100:103], v[28:31]
    s_waitcnt lgkmcnt(6)
    v_mfma_f32_16x16x32_bf16 v[56:59], v[84:87], v[100:103], v[56:59]
    s_waitcnt lgkmcnt(4)
    v_mfma_f32_16x16x32_bf16 v[28:31], v[72:75], v[104:107], v[28:31]
    s_waitcnt lgkmcnt(3)
    v_mfma_f32_16x16x32_bf16 v[56:59], v[88:91], v[104:107], v[56:59]
    s_waitcnt lgkmcnt(1)
    v_mfma_f32_16x16x32_bf16 v[28:31], v[76:79], v[108:111], v[28:31]
    s_waitcnt lgkmcnt(0)
    v_mfma_f32_16x16x32_bf16 v[56:59], v[92:95], v[108:111], v[56:59]
    s_nop 7
    v_cndmask_b32 v60, v56, v28, vcc
    v_cndmask_b32 v61, v57, v29, vcc
    v_cndmask_b32 v62, v58, v30, vcc
    v_cndmask_b32 v63, v59, v31, vcc
    v_cndmask_b32 v28, v28, v56, vcc
    v_cndmask_b32 v29, v29, v57, vcc
    v_cndmask_b32 v30, v30, v58, vcc
    v_cndmask_b32 v31, v31, v59, vcc
    v_add_f32_dpp v28, v60, v28 row_ror:4 row_mask:0xf bank_mask:0xf
    v_add_f32_dpp v29, v61, v29 row_ror:4 row_mask:0xf bank_mask:0xf
    v_add_f32_dpp v30, v62, v30 row_ror:4 row_mask:0xf bank_mask:0xf
    v_add_f32_dpp v31, v63, v31 row_ror:4 row_mask:0xf bank_mask:0xf
    v_add_f32_dpp v28, v28, v28 row_ror:8 row_mask:0xf bank_mask:0xf
    v_add_f32_dpp v29, v29, v29 row_ror:8 row_mask:0xf bank_mask:0xf
    v_add_f32_dpp v30, v30, v30 row_ror:8 row_mask:0xf bank_mask:0xf
    v_add_f32_dpp v31, v31, v31 row_ror:8 row_mask:0xf bank_mask:0xf
    v_mul_f32 v28, s74, v28
    v_mul_f32 v29, s74, v29
    v_mul_f32 v30, s74, v30
    v_mul_f32 v31, s74, v31
    v_cvt_pk_bf16_f32 v48, v28, v29
    v_cvt_pk_bf16_f32 v49, v30, v31
    v_min_u32 v48, -2, v48
    v_min_u32 v49, -2, v49
    s_mov_b32 exec_lo, 0x00ff00ff
    s_mov_b32 exec_hi, 0x00ff00ff
    buffer_store_dwordx2 v[48:49], v54, s[48:51], s72 offen sc1
    s_mov_b64 exec, -1
    s_barrier
    s_cmp_lt_u32 s65, 3
    s_cbranch_scc1 L_TH
    s_lshl_b32 s71, s65, 1
    s_add_u32 s71, s71, s64
    s_lshr_b32 s72, s64, 1
    s_cmp_eq_u32 s65, 3
    s_cselect_b32 s72, s72, 2
    s_sub_u32 s71, s71, s72
    s_mul_i32 s76, s45, 9
    s_add_u32 s76, s76, s71
    s_cmp_eq_u32 s69, 0
    s_cselect_b32 s60, s30, s32
    s_cselect_b32 s61, s31, s33
    s_mov_b32 s62, 5308416
    s_lshl_b32 s72, s67, 1
    s_lshl_b32 s71, s69, 2
    s_or_b32 s72, s72, s71
    v_bfe_u32 v14, v2, 1, 1
    v_or_b32 v14, s72, v14
    v_xor_b32 v14, v14, v3
    v_lshlrev_b32 v14, 4, v14
    v_mul_u32_u24 v12, 9216, v2
    v_add_u32 v12, v12, v14
    s_lshl_b32 s71, s70, 1
    s_add_u32 s71, s71, s67
    s_mul_i32 s72, s71, 73728
    s_lshl_b32 s74, s76, 7
    s_add_u32 s72, s72, s74
    s_lshl_b32 s71, s71, 1
    s_add_u32 s71, s71, s69
    s_lshl_b32 s71, s71, 10
    s_add_u32 s71, s71, 16384
    s_branch L_F
L_TH:
    s_lshl_b32 s66, s65, 1
    s_add_u32 s66, s66, s64
    s_mov_b32 s41, 99
    s_cmp_eq_u32 s66, 3
    s_cbranch_scc1 L_f_go
    s_cmp_gt_u32 s66, 3
    s_subb_u32 s66, s66, 0
    s_lshl_b32 s66, s66, 3
    s_add_u32 s41, s66, s45
    s_add_u32 s66, s66, s44
    s_cmp_ge_u32 s41, 36
    s_cbranch_scc1 L_noclr2
    v_mov_b32 v24, -1
    v_mov_b32 v25, -1
    v_mov_b32 v26, -1
    v_mov_b32 v27, -1
    s_lshl_b32 s74, s41, 14
    s_lshl_b32 s75, s44, 11
    s_add_u32 s74, s74, s75
    s_add_u32 s74, s74, 2097152
    buffer_store_dwordx4 v[24:27], v9, s[48:51], s74 offen offset:0 sc1
    buffer_store_dwordx4 v[24:27], v9, s[48:51], s74 offen offset:1024 sc1
    s_waitcnt vmcnt(0)
    s_barrier
    s_cmp_lg_u32 s44, 0
    s_cbranch_scc1 L_noclr2
    s_lshl_b32 s74, s41, 7
    s_add_u32 s74, s74, 65536
    v_mov_b32 v14, s43
    v_lshlrev_b32 v17, 2, v1
    s_mov_b32 exec_hi, 0
    buffer_store_dword v14, v17, s[48:51], s74 offen sc1
    s_mov_b64 exec, -1
L_noclr2:
L_noclr:
    s_cmp_eq_u32 s67, 0
    s_cselect_b32 s52, s30, s32
    s_cselect_b32 s53, s31, s33
    s_mov_b32 s54, 5308416
    s_lshr_b32 s71, s66, 1
    s_add_u32 s71, s71, 32
    s_mul_i32 s71, s71, 73728
    s_sub_u32 s72, 3, s45
    s_and_b32 s72, s72, 7
    s_mul_i32 s73, s45, 9
    s_lshl_b32 s73, s73, 7
    s_add_u32 s71, s71, s73
    s_lshl_b32 s74, s72, 7
    s_add_u32 s73, s71, s74
    v_mul_u32_u24 v14, 9216, v2
    v_lshl_add_u32 v14, v3, 4, v14
    s_add_u32 s74, s73, 1474560
    s_add_u32 s71, s71, 1474560
    buffer_load_dwordx4 v[248:251], v14, s[52:55], s73 offen
    buffer_load_dwordx4 v[248:251], v14, s[52:55], s74 offen
    s_cmp_lg_u32 s72, 0
    s_cbranch_scc1 L_noc3b
    buffer_load_dwordx4 v[248:251], v14, s[52:55], s73 offen offset:1024
    buffer_load_dwordx4 v[248:251], v14, s[52:55], s74 offen offset:1024
L_noc3b:
    s_lshl_b32 s66, s66, 10
    s_mov_b32 s52, s26
    s_mov_b32 s53, s27
    s_lshl_b32 s73, s45, 3
    s_add_u32 s73, s73, 7
    s_mul_i32 s73, s73, 73728
    s_add_u32 s54, s73, 73728
    s_add_u32 s73, s73, s66
    s_add_u32 s74, s73, 40960
    buffer_load_dwordx4 v[248:251], v9, s[52:55], s73 offen
    buffer_load_dwordx4 v[248:251], v9, s[52:55], s74 offen
L_f_go:
    s_mul_i32 s40, s45, 7
    s_lshl_b32 s74, s65, 1
    s_add_u32 s40, s40, s74
    s_add_u32 s40, s40, s64
    s_mov_b32 s52, s24
    s_mov_b32 s53, s25
    s_mov_b32 s54, 4194304
    s_mov_b32 s55, 0x20000
    s_mov_b32 s56, s26
    s_mov_b32 s57, s27
    s_mov_b32 s58, 4718592
    s_mov_b32 s59, 0x20000
    s_lshl_b32 s71, s44, 10
    s_add_u32 s71, s71, 16384
    s_lshl_b32 s72, s68, 2
    s_add_u32 s72, s72, s67
    s_lshl_b32 s72, s72, 16
    s_lshl_b32 s73, s47, 1
    s_add_u32 s73, s73, s64
    s_lshl_b32 s74, s73, 7
    s_add_u32 s72, s72, s74
    s_mov_b32 m0, s71
    s_add_u32 s74, s72, 0
    buffer_load_dwordx4 v12, s[52:55], s74 offen nt lds
    s_add_u32 s71, s71, 8192
    s_mov_b32 m0, s71
    s_add_u32 s74, s72, 131072
    buffer_load_dwordx4 v12, s[52:55], s74 offen nt lds
    s_add_u32 s71, s71, 8192
    s_mov_b32 m0, s71
    s_add_u32 s74, s72, 1048576
    buffer_load_dwordx4 v12, s[52:55], s74 offen nt lds
    s_add_u32 s71, s71, 8192
    s_mov_b32 m0, s71
    s_add_u32 s74, s72, 1179648
    buffer_load_dwordx4 v12, s[52:55], s74 offen nt lds
    s_add_u32 s71, s71, 8192
    s_mov_b32 m0, s71
    s_add_u32 s74, s72, 2097152
    buffer_load_dwordx4 v12, s[52:55], s74 offen nt lds
    s_add_u32 s71, s71, 8192
    s_mov_b32 m0, s71
    s_add_u32 s74, s72, 2228224
    buffer_load_dwordx4 v12, s[52:55], s74 offen nt lds
    s_add_u32 s71, s71, 8192
    s_mov_b32 m0, s71
    s_add_u32 s74, s72, 3145728
    buffer_load_dwordx4 v12, s[52:55], s74 offen nt lds
    s_add_u32 s71, s71, 8192
    s_mov_b32 m0, s71
    s_add_u32 s74, s72, 3276800
    buffer_load_dwordx4 v12, s[52:55], s74 offen nt lds
    s_add_u32 s71, s71, 8192
    v_mul_u32_u24 v14, 1152, v2
    v_add_u32 v14, v14, v11
    s_mul_i32 s73, s73, 73728
    s_lshl_b32 s71, s67, 3
    s_add_u32 s71, s71, s68
    s_lshl_b32 s71, s71, 10
    s_add_u32 s71, s71, 81920
    s_mul_i32 s72, s67, 9216
    s_lshl_b32 s74, s68, 7
    s_add_u32 s72, s72, s74
    s_add_u32 s72, s72, s73
    s_mul_i32 s72, s44, 9216
    s_add_u32 s72, s72, s73
    s_lshl_b32 s71, s44, 13
    s_add_u32 s71, s71, 81920
    s_add_u32 m0, s71, 0
    s_add_u32 s74, s72, 0
    buffer_load_dwordx4 v14, s[56:59], s74 offen nt lds
    s_add_u32 m0, s71, 1024
    s_add_u32 s74, s72, 128
    buffer_load_dwordx4 v14, s[56:59], s74 offen nt lds
    s_add_u32 m0, s71, 2048
    s_add_u32 s74, s72, 256
    buffer_load_dwordx4 v14, s[56:59], s74 offen nt lds
    s_add_u32 m0, s71, 3072
    s_add_u32 s74, s72, 384
    buffer_load_dwordx4 v14, s[56:59], s74 offen nt lds
    s_add_u32 m0, s71, 4096
    s_add_u32 s74, s72, 512
    buffer_load_dwordx4 v14, s[56:59], s74 offen nt lds
    s_add_u32 m0, s71, 5120
    s_add_u32 s74, s72, 640
    buffer_load_dwordx4 v14, s[56:59], s74 offen nt lds
    s_add_u32 m0, s71, 6144
    s_add_u32 s74, s72, 768
    buffer_load_dwordx4 v14, s[56:59], s74 offen nt lds
    s_add_u32 m0, s71, 7168
    s_add_u32 s74, s72, 896
    buffer_load_dwordx4 v14, s[56:59], s74 offen nt lds
    s_mul_i32 s72, s44, 9216
    s_add_u32 s72, s72, s73
    s_add_u32 s72, s72, 1024
    s_lshl_b32 s71, s44, 10
    s_add_u32 s71, s71, 147456
    s_mov_b32 m0, s71
    s_nop 0
    buffer_load_dwordx4 v14, s[56:59], s72 offen nt lds
    v_lshl_add_u32 v16, v4, 13, v15
    v_add_u32 v16, 65536, v16
    v_add_u32 v17, 0x10000, v16
    v_lshl_add_u32 v18, v4, 10, v13
    v_add_u32 v18, 147456, v18
    v_lshl_add_u32 v19, v4, 10, v13
    v_add_u32 v19, 16384, v19
    v_lshlrev_b32 v21, 11, v3
    v_xor_b32 v22, v3, v4
    v_lshlrev_b32 v22, 4, v22
    v_lshl_add_u32 v22, v2, 11, v22
    v_and_b32 v12, 1, v2
    v_lshl_or_b32 v12, v12, 2, v4
    v_lshrrev_b32 v14, 1, v3
    v_xor_b32 v12, v12, v14
    v_lshlrev_b32 v12, 4, v12
    v_lshl_add_u32 v12, v3, 7, v12
    v_lshlrev_b32 v14, 3, v3
    s_lshl_b32 s66, s47, 14
    s_add_u32 s66, s66, 1310720
    s_lshl_b32 s73, s44, 7
    s_add_u32 s73, s73, s66
    s_lshl_b32 s72, s40, 7
    s_add_u32 s72, s72, 2097152
    v_lshrrev_b32 v23, 1, v3
    v_mul_u32_u24 v23, 320, v23
    v_lshl_add_u32 v23, v4, 3, v23
    s_lshl_b32 s74, s44, 5
    v_add_u32 v23, s74, v23
    v_mul_u32_u24 v10, 320, v6
    v_lshl_add_u32 v10, v4, 4, v10
    s_mul_i32 s74, s44, 16384
    s_add_u32 s72, s72, s74
    v_mul_u32_u24 v20, 131072, v5
    v_lshl_add_u32 v20, v4, 5, v20
    v_lshl_add_u32 v20, v6, 3, v20
    v_lshlrev_b32 v232, 2, v1
    ds_write_b32 v232, v8 offset:15360
    v_mov_b32 v236, 7168
    v_cmp_eq_u32 vcc, 0, v5
    s_nop 1
    v_cndmask_b32 v232, v236, v10, vcc
    v_cmp_eq_u32 vcc, 1, v5
    s_nop 1
    v_cndmask_b32 v233, v236, v10, vcc
    v_cmp_eq_u32 vcc, 2, v5
    s_nop 1
    v_cndmask_b32 v234, v236, v10, vcc
    v_cmp_eq_u32 vcc, 3, v5
    s_nop 1
    v_cndmask_b32 v235, v236, v10, vcc
    s_waitcnt vmcnt(9)
    s_barrier
    ds_read_b64_tr_b16 v[32:33], v19 offset:0
    ds_read_b64_tr_b16 v[34:35], v19 offset:512
    ds_read_b64_tr_b16 v[36:37], v19 offset:4096
    ds_read_b64_tr_b16 v[38:39], v19 offset:4608
    ds_read_b64_tr_b16 v[40:41], v19 offset:8192
    ds_read_b64_tr_b16 v[42:43], v19 offset:8704
    ds_read_b64_tr_b16 v[44:45], v19 offset:12288
    ds_read_b64_tr_b16 v[46:47], v19 offset:12800
    ds_read_b64_tr_b16 v[48:49], v19 offset:16384
    ds_read_b64_tr_b16 v[50:51], v19 offset:16896
    ds_read_b64_tr_b16 v[52:53], v19 offset:20480
    ds_read_b64_tr_b16 v[54:55], v19 offset:20992
    s_waitcnt lgkmcnt(4)
    ds_read_b64_tr_b16 v[56:57], v19 offset:24576
    ds_read_b64_tr_b16 v[58:59], v19 offset:25088
    ds_read_b64_tr_b16 v[60:61], v19 offset:28672
    ds_read_b64_tr_b16 v[62:63], v19 offset:29184
    ds_read_b64_tr_b16 v[64:65], v19 offset:32768
    ds_read_b64_tr_b16 v[66:67], v19 offset:33280
    ds_read_b64_tr_b16 v[68:69], v19 offset:36864
    ds_read_b64_tr_b16 v[70:71], v19 offset:37376
    ds_read_b64_tr_b16 v[72:73], v19 offset:40960
    ds_read_b64_tr_b16 v[74:75], v19 offset:41472
    ds_read_b64_tr_b16 v[76:77], v19 offset:45056
    ds_read_b64_tr_b16 v[78:79], v19 offset:45568
    s_waitcnt lgkmcnt(4)
    ds_read_b64_tr_b16 v[80:81], v19 offset:49152
    ds_read_b64_tr_b16 v[82:83], v19 offset:49664
    ds_read_b64_tr_b16 v[84:85], v19 offset:53248
    ds_read_b64_tr_b16 v[86:87], v19 offset:53760
    ds_read_b64_tr_b16 v[88:89], v19 offset:57344
    ds_read_b64_tr_b16 v[90:91], v19 offset:57856
    ds_read_b64_tr_b16 v[92:93], v19 offset:61440
    ds_read_b64_tr_b16 v[94:95], v19 offset:61952
    s_sub_u32 s41, s40, s45
    s_lshl1_add_u32 s41, s41, s70
    s_mov_b32 s52, s16
    s_mov_b32 s53, s17
    s_mov_b32 s54, 4608
    s_mov_b32 s55, 0x20000
    s_mov_b32 s56, s36
    s_mov_b32 s57, s37
    s_mov_b32 s58, 4608
    s_mov_b32 s59, 0x20000
    v_and_b32 v212, 1, v4
    v_lshl_add_u32 v212, v3, 1, v212
    v_and_b32 v213, 3, v212
    v_mul_u32_u24 v213, 1152, v213
    v_lshrrev_b32 v212, 2, v212
    v_lshl_add_u32 v213, v212, 3, v213
    s_min_u32 s75, s41, 35
    s_lshl_b32 s75, s75, 5
    v_add_u32 v213, s75, v213
    buffer_load_dwordx2 v[214:215], v213, s[52:55], 0 offen
    v_and_b32 v212, 1, v3
    v_lshlrev_b32 v212, 4, v212
    v_mov_b32 v216, 0x3f80
    v_lshlrev_b32 v216, v212, v216
    v_bfe_u32 v212, v1, 1, 3
    v_cmp_eq_u32 vcc, 0, v212
    s_nop 1
    v_cndmask_b32 v220, 0, v216, vcc
    v_cmp_eq_u32 vcc, 1, v212
    s_nop 1
    v_cndmask_b32 v221, 0, v216, vcc
    v_cmp_eq_u32 vcc, 2, v212
    s_nop 1
    v_cndmask_b32 v222, 0, v216, vcc
    v_cmp_eq_u32 vcc, 3, v212
    s_nop 1
    v_cndmask_b32 v223, 0, v216, vcc
    v_cmp_eq_u32 vcc, 4, v212
    s_nop 1
    v_cndmask_b32 v224, 0, v216, vcc
    v_cmp_eq_u32 vcc, 5, v212
    s_nop 1
    v_cndmask_b32 v225, 0, v216, vcc
    v_cmp_eq_u32 vcc, 6, v212
    s_nop 1
    v_cndmask_b32 v226, 0, v216, vcc
    v_cmp_eq_u32 vcc, 7, v212
    s_nop 1
    v_cndmask_b32 v227, 0, v216, vcc
    v_min_u32 v238, 35, v1
    v_lshlrev_b32 v238, 7, v238
    s_mov_b32 s76, 65536
    v_mov_b32 v28, 0
    v_mov_b32 v29, 0
    s_cmp_lg_u32 s44, 0
    s_cbranch_scc1 L_ue1
    buffer_load_dword v239, v238, s[48:51], s76 offen sc1
L_ue1:
    buffer_load_dwordx4 v[24:27], v22, s[48:51], s73 offen sc1
    s_cmp_lg_u32 s44, 7
    s_cbranch_scc1 L_ue2
    s_mov_b64 exec, 0xff
    buffer_load_dwordx2 v[28:29], v21, s[48:51], s66 offen offset:1024 sc1
    s_mov_b64 exec, -1
L_ue2:
    s_waitcnt vmcnt(0) lgkmcnt(2)
    s_barrier
    ds_read_b64_tr_b16 v[96:97], v16 offset:0
    ds_read_b64_tr_b16 v[98:99], v16 offset:512
    ds_read_b64_tr_b16 v[100:101], v16 offset:32768
    ds_read_b64_tr_b16 v[102:103], v16 offset:33280
    ds_read_b64_tr_b16 v[104:105], v16 offset:2048
    ds_read_b64_tr_b16 v[106:107], v16 offset:2560
    ds_read_b64_tr_b16 v[108:109], v16 offset:34816
    ds_read_b64_tr_b16 v[110:111], v16 offset:35328
    ds_read_b64_tr_b16 v[112:113], v16 offset:4096
    ds_read_b64_tr_b16 v[114:115], v16 offset:4608
    ds_read_b64_tr_b16 v[116:117], v16 offset:36864
    ds_read_b64_tr_b16 v[118:119], v16 offset:37376
    s_waitcnt lgkmcnt(4)
    ds_read_b64_tr_b16 v[120:121], v16 offset:6144
    ds_read_b64_tr_b16 v[122:123], v16 offset:6656
    ds_read_b64_tr_b16 v[124:125], v16 offset:38912
    ds_read_b64_tr_b16 v[126:127], v16 offset:39424
    s_waitcnt lgkmcnt(4)
    ds_read_b64_tr_b16 v[128:129], v18 offset:0
    ds_read_b64_tr_b16 v[130:131], v18 offset:512
    ds_read_b64_tr_b16 v[132:133], v18 offset:4096
    ds_read_b64_tr_b16 v[134:135], v18 offset:4608
    s_mov_b32 s77, 0
    s_cmp_lg_u32 s44, 0
    s_cbranch_scc1 L_upd
L_upp:
    v_cmp_ne_u32 vcc, s43, v239
    s_add_u32 s77, s77, 1
    s_cbranch_vccz L_upd
    s_cmp_ge_u32 s77, 400000
    s_cbranch_scc1 L_upd
    buffer_load_dword v239, v238, s[48:51], s76 offen sc1
    s_waitcnt vmcnt(0)
    s_branch L_upp
L_upd:
    s_mov_b32 s77, 0
    s_branch L_uchk
L_upoll:
    buffer_load_dwordx4 v[24:27], v22, s[48:51], s73 offen sc1
    s_cmp_lg_u32 s44, 7
    s_cbranch_scc1 L_uns
    s_mov_b64 exec, 0xff
    buffer_load_dwordx2 v[28:29], v21, s[48:51], s66 offen offset:1024 sc1
    s_mov_b64 exec, -1
L_uns:
    s_add_u32 s77, s77, 1
    s_waitcnt vmcnt(0)
L_uchk:
    v_max3_u32 v30, v24, v25, v26
    v_max3_u32 v30, v30, v27, v28
    v_max_u32 v30, v30, v29
    v_cmp_eq_u32 vcc, -1, v30
    s_cmp_ge_u32 s77, 400000
    s_cbranch_scc1 L_udone
    s_cbranch_vccnz L_upoll
L_udone:
    ds_write_b128 v7, v[24:27] offset:0
    s_cmp_lg_u32 s44, 7
    s_cbranch_scc1 L_unw
    s_mov_b64 exec, 0xff
    ds_write_b64 v14, v[28:29] offset:10240
    s_mov_b64 exec, -1
L_unw:
    s_waitcnt lgkmcnt(0)
    s_barrier
    s_cmp_lg_u32 s70, 0
    s_cbranch_scc1 L_unouv
    ds_read_b64 v[28:29], v14 offset:10240
    ds_read_b128 v[176:179], v12 offset:0
    ds_read_b128 v[180:183], v12 offset:1024
    ds_read_b128 v[184:187], v12 offset:2048
    ds_read_b128 v[188:191], v12 offset:3072
    ds_read_b128 v[192:195], v12 offset:4096
    ds_read_b128 v[196:199], v12 offset:5120
    ds_read_b128 v[200:203], v12 offset:6144
    ds_read_b128 v[204:207], v12 offset:7168
    s_waitcnt lgkmcnt(7)
    v_mfma_f32_16x16x32_bf16 v[24:27], v[32:35], v[176:179], 0
    v_mfma_f32_16x16x32_bf16 v[208:211], v[36:39], v[176:179], 0
    v_max_f32_dpp v30, v28, v28 quad_perm:[1,0,3,2] row_mask:0xf bank_mask:0xf
    s_waitcnt lgkmcnt(6)
    v_mfma_f32_16x16x32_bf16 v[24:27], v[40:43], v[180:183], v[24:27]
    v_mfma_f32_16x16x32_bf16 v[208:211], v[44:47], v[180:183], v[208:211]
    v_sub_f32 v30, v28, v30
    s_waitcnt lgkmcnt(5)
    v_mfma_f32_16x16x32_bf16 v[24:27], v[48:51], v[184:187], v[24:27]
    v_mfma_f32_16x16x32_bf16 v[208:211], v[52:55], v[184:187], v[208:211]
    v_exp_f32 v30, v30
    s_waitcnt lgkmcnt(4)
    v_mfma_f32_16x16x32_bf16 v[24:27], v[56:59], v[188:191], v[24:27]
    v_mfma_f32_16x16x32_bf16 v[208:211], v[60:63], v[188:191], v[208:211]
    v_mul_f32 v31, v30, v29
    s_waitcnt lgkmcnt(3)
    v_mfma_f32_16x16x32_bf16 v[24:27], v[64:67], v[192:195], v[24:27]
    v_mfma_f32_16x16x32_bf16 v[208:211], v[68:71], v[192:195], v[208:211]
    v_add_f32_dpp v31, v31, v31 quad_perm:[1,0,3,2] row_mask:0xf bank_mask:0xf
    s_waitcnt lgkmcnt(2)
    v_mfma_f32_16x16x32_bf16 v[24:27], v[72:75], v[196:199], v[24:27]
    v_mfma_f32_16x16x32_bf16 v[208:211], v[76:79], v[196:199], v[208:211]
    v_rcp_f32 v31, v31
    s_waitcnt lgkmcnt(1)
    v_mfma_f32_16x16x32_bf16 v[24:27], v[80:83], v[200:203], v[24:27]
    v_mfma_f32_16x16x32_bf16 v[208:211], v[84:87], v[200:203], v[208:211]
    v_mul_f32 v30, v30, v31
    s_waitcnt lgkmcnt(0)
    v_mfma_f32_16x16x32_bf16 v[24:27], v[88:91], v[204:207], v[24:27]
    v_mfma_f32_16x16x32_bf16 v[208:211], v[92:95], v[204:207], v[208:211]
    s_nop 7
    v_add_f32_dpp v24, v208, v24 row_ror:8 row_mask:0xf bank_mask:0xf
    v_add_f32_dpp v25, v209, v25 row_ror:8 row_mask:0xf bank_mask:0xf
    v_add_f32_dpp v26, v210, v26 row_ror:8 row_mask:0xf bank_mask:0xf
    v_add_f32_dpp v27, v211, v27 row_ror:8 row_mask:0xf bank_mask:0xf
    v_mul_f32 v24, v24, v30
    v_mul_f32 v25, v25, v30
    v_mul_f32 v26, v26, v30
    v_mul_f32 v27, v27, v30
    v_add_f32_dpp v24, v24, v24 quad_perm:[1,0,3,2] row_mask:0xf bank_mask:0xf
    v_add_f32_dpp v25, v25, v25 quad_perm:[1,0,3,2] row_mask:0xf bank_mask:0xf
    v_add_f32_dpp v26, v26, v26 quad_perm:[1,0,3,2] row_mask:0xf bank_mask:0xf
    v_add_f32_dpp v27, v27, v27 quad_perm:[1,0,3,2] row_mask:0xf bank_mask:0xf
    v_cvt_pk_bf16_f32 v28, v24, v25
    v_cvt_pk_bf16_f32 v29, v26, v27
    s_mov_b32 exec_lo, 0x00550055
    s_mov_b32 exec_hi, 0x00550055
    ds_write_b64 v23, v[28:29] offset:8192
    s_mov_b64 exec, -1
    s_waitcnt lgkmcnt(0)
L_unouv:
    s_barrier
    ds_read_b128 v[176:179], v233 offset:8192
    ds_read_b128 v[180:183], v233 offset:8256
    ds_read_b128 v[184:187], v234 offset:8192
    ds_read_b128 v[188:191], v234 offset:8256
    ds_read_b128 v[192:195], v235 offset:8192
    ds_read_b128 v[196:199], v235 offset:8256
    ds_read_b128 v[200:203], v232 offset:8192
    ds_read_b128 v[204:207], v232 offset:8256
    s_add_u32 s74, s72, 524288
    s_cmp_lg_u32 s70, 0
    s_waitcnt lgkmcnt(7)
    v_mfma_f32_16x16x32_bf16 v[240:243], v[104:107], v[176:179], 0
    s_waitcnt lgkmcnt(6)
    v_mfma_f32_16x16x32_bf16 v[240:243], v[108:111], v[180:183], v[240:243]
    s_waitcnt lgkmcnt(5)
    v_mfma_f32_16x16x32_bf16 v[240:243], v[112:115], v[184:187], v[240:243]
    s_waitcnt lgkmcnt(4)
    v_mfma_f32_16x16x32_bf16 v[240:243], v[116:119], v[188:191], v[240:243]
    s_waitcnt lgkmcnt(3)
    v_mfma_f32_16x16x32_bf16 v[240:243], v[120:123], v[192:195], v[240:243]
    s_waitcnt lgkmcnt(2)
    v_mfma_f32_16x16x32_bf16 v[240:243], v[124:127], v[196:199], v[240:243]
    s_waitcnt lgkmcnt(1)
    v_mfma_f32_16x16x32_bf16 v[240:243], v[96:99], v[200:203], v[240:243]
    s_waitcnt lgkmcnt(0)
    v_mfma_f32_16x16x32_bf16 v[240:243], v[100:103], v[204:207], v[240:243]
    s_cbranch_scc1 L_ug_a
    v_mfma_f32_16x16x32_bf16 v[244:247], v[128:131], v[200:203], 0
    v_mfma_f32_16x16x32_bf16 v[244:247], v[132:135], v[204:207], v[244:247]
    s_nop 4
    v_cvt_pk_bf16_f32 v240, v240, v241
    v_cvt_pk_bf16_f32 v241, v242, v243
    buffer_store_dwordx2 v[240:241], v20, s[48:51], s72 offen sc1
    v_cvt_pk_bf16_f32 v244, v244, v245
    v_cvt_pk_bf16_f32 v245, v246, v247
    s_mov_b64 exec, s[78:79]
    buffer_store_dwordx2 v[244:245], v20, s[48:51], s74 offen sc1
    s_mov_b64 exec, -1
    s_branch L_ug_b
L_ug_a:
    s_nop 6
    v_cvt_pk_bf16_f32 v240, v240, v241
    v_cvt_pk_bf16_f32 v241, v242, v243
    buffer_store_dwordx2 v[240:241], v20, s[48:51], s72 offen sc1
L_ug_b:
    s_cmp_ge_u32 s41, 36
    s_cbranch_scc1 L_end
    s_and_b32 s66, s44, 3
    s_lshl_b32 s72, s41, 14
    s_lshl_b32 s73, s66, 12
    s_add_u32 s72, s72, s73
    s_add_u32 s72, s72, 2097152
    s_mov_b32 s76, 15
    s_mov_b32 s77, 0
L_finpoll:
    s_bitcmp1_b32 s76, 0
    s_cbranch_scc0 L_fi0
    buffer_load_dwordx4 v[32:35], v9, s[48:51], s72 offen offset:0 sc1
L_fi0:
    s_bitcmp1_b32 s76, 1
    s_cbranch_scc0 L_fi1
    buffer_load_dwordx4 v[36:39], v9, s[48:51], s72 offen offset:1024 sc1
L_fi1:
    s_bitcmp1_b32 s76, 2
    s_cbranch_scc0 L_fi2
    buffer_load_dwordx4 v[40:43], v9, s[48:51], s72 offen offset:2048 sc1
L_fi2:
    s_bitcmp1_b32 s76, 3
    s_cbranch_scc0 L_fi3
    buffer_load_dwordx4 v[44:47], v9, s[48:51], s72 offen offset:3072 sc1
L_fi3:
    s_add_u32 s77, s77, 1
    s_waitcnt vmcnt(0)
    v_max3_u32 v48, v32, v33, v34
    v_max3_u32 v49, v36, v37, v38
    v_max3_u32 v50, v40, v41, v42
    v_max3_u32 v51, v44, v45, v46
    v_max_u32 v48, v48, v35
    v_max_u32 v49, v49, v39
    v_max_u32 v50, v50, v43
    v_max_u32 v51, v51, v47
    v_cmp_eq_u32 vcc, -1, v48
    s_nop 0
    s_cbranch_vccnz L_fc0
    s_bitset0_b32 s76, 0
L_fc0:
    v_cmp_eq_u32 vcc, -1, v49
    s_nop 0
    s_cbranch_vccnz L_fc1
    s_bitset0_b32 s76, 1
L_fc1:
    v_cmp_eq_u32 vcc, -1, v50
    s_nop 0
    s_cbranch_vccnz L_fc2
    s_bitset0_b32 s76, 2
L_fc2:
    v_cmp_eq_u32 vcc, -1, v51
    s_nop 0
    s_cbranch_vccnz L_fc3
    s_bitset0_b32 s76, 3
L_fc3:
    s_cmp_ge_u32 s77, 400000
    s_cbranch_scc1 L_findone
    s_cmp_lg_u32 s76, 0
    s_cbranch_scc1 L_finpoll
L_findone:
    s_cmp_ge_u32 s66, 2
    s_cbranch_scc1 L_fin_g
    v_mfma_f32_16x16x32_bf16 v[52:55], v[220:223], v[32:35], 0
    v_mfma_f32_16x16x32_bf16 v[52:55], v[220:223], v[36:39], v[52:55]
    v_mfma_f32_16x16x32_bf16 v[52:55], v[220:223], v[40:43], v[52:55]
    s_cmp_eq_u32 s66, 1
    s_cbranch_scc1 L_fin_g3
    v_mfma_f32_16x16x32_bf16 v[52:55], v[220:223], v[44:47], v[52:55]
    s_branch L_fin_w
L_fin_g:
    v_mfma_f32_16x16x32_bf16 v[52:55], v[224:227], v[32:35], 0
    v_mfma_f32_16x16x32_bf16 v[52:55], v[224:227], v[36:39], v[52:55]
    v_mfma_f32_16x16x32_bf16 v[52:55], v[224:227], v[40:43], v[52:55]
L_fin_g3:
    v_mfma_f32_16x16x32_bf16 v[52:55], v[224:227], v[44:47], v[52:55]
L_fin_w:
    s_nop 7
    ds_write_b128 v7, v[52:55] offset:16384
    s_waitcnt lgkmcnt(0)
    s_barrier
    s_cmp_lg_u32 s66, 0
    s_cbranch_scc1 L_end
    ds_read_b128 v[64:67], v7 offset:16384
    ds_read_b128 v[68:71], v7 offset:17408
    ds_read_b128 v[72:75], v7 offset:18432
    ds_read_b128 v[76:79], v7 offset:19456
    s_mov_b32 s76, 0xbfb8aa3b
    v_lshlrev_b32 v32, 16, v214
    v_and_b32 v33, 0xffff0000, v214
    v_lshlrev_b32 v34, 16, v215
    v_and_b32 v35, 0xffff0000, v215
    s_waitcnt lgkmcnt(2)
    v_add_f32 v64, v64, v68
    v_add_f32 v65, v65, v69
    v_add_f32 v66, v66, v70
    v_add_f32 v67, v67, v71
    s_waitcnt lgkmcnt(0)
    v_add_f32 v72, v72, v76
    v_add_f32 v73, v73, v77
    v_add_f32 v74, v74, v78
    v_add_f32 v75, v75, v79
    v_add_f32 v64, v64, v72
    v_add_f32 v65, v65, v73
    v_add_f32 v66, v66, v74
    v_add_f32 v67, v67, v75
    v_add_f32_dpp v64, v64, v64 row_ror:8 row_mask:0xf bank_mask:0xf
    v_add_f32_dpp v65, v65, v65 row_ror:8 row_mask:0xf bank_mask:0xf
    v_add_f32_dpp v66, v66, v66 row_ror:8 row_mask:0xf bank_mask:0xf
    v_add_f32_dpp v67, v67, v67 row_ror:8 row_mask:0xf bank_mask:0xf
    v_cvt_pk_bf16_f32 v64, v64, v64
    v_lshlrev_b32 v64, 16, v64
    v_cvt_pk_bf16_f32 v65, v65, v65
    v_lshlrev_b32 v65, 16, v65
    v_cvt_pk_bf16_f32 v66, v66, v66
    v_lshlrev_b32 v66, 16, v66
    v_cvt_pk_bf16_f32 v67, v67, v67
    v_lshlrev_b32 v67, 16, v67
    v_mul_f32 v76, s76, v64
    v_mul_f32 v77, s76, v65
    v_mul_f32 v78, s76, v66
    v_mul_f32 v79, s76, v67
    v_exp_f32 v76, v76
    v_exp_f32 v77, v77
    v_exp_f32 v78, v78
    v_exp_f32 v79, v79
    v_add_f32 v76, 1.0, v76
    v_add_f32 v77, 1.0, v77
    v_add_f32 v78, 1.0, v78
    v_add_f32 v79, 1.0, v79
    v_rcp_f32 v76, v76
    v_rcp_f32 v77, v77
    v_rcp_f32 v78, v78
    v_rcp_f32 v79, v79
    v_mul_f32 v76, v64, v76
    v_mul_f32 v77, v65, v77
    v_mul_f32 v78, v66, v78
    v_mul_f32 v79, v67, v79
    v_cvt_pk_bf16_f32 v76, v76, v77
    v_cvt_pk_bf16_f32 v77, v78, v79
    s_nop 0
    v_permlane32_swap_b32 v76, v68
    v_permlane32_swap_b32 v77, v69
    v_lshlrev_b32 v72, 16, v68
    v_and_b32 v73, 0xffff0000, v68
    v_lshlrev_b32 v74, 16, v69
    v_and_b32 v75, 0xffff0000, v69
    v_mul_f32 v64, v64, v72
    v_mul_f32 v65, v65, v73
    v_mul_f32 v66, v66, v74
    v_mul_f32 v67, v67, v75
    v_cvt_pk_bf16_f32 v68, v64, v65
    v_cvt_pk_bf16_f32 v69, v66, v67
    v_lshlrev_b32 v64, 16, v68
    v_and_b32 v65, 0xffff0000, v68
    v_lshlrev_b32 v66, 16, v69
    v_and_b32 v67, 0xffff0000, v69
    v_add_f32 v64, v64, v32
    v_add_f32 v65, v65, v33
    v_add_f32 v66, v66, v34
    v_add_f32 v67, v67, v35
    v_cvt_pk_bf16_f32 v64, v64, v65
    v_cvt_pk_bf16_f32 v65, v66, v67
    s_mov_b64 exec, 0x00ff00ff
    buffer_store_dwordx2 v[64:65], v213, s[56:59], 0 offen
    s_cmp_lg_u32 s41, 0
    s_cbranch_scc1 L_fin_noep
    s_mov_b64 exec, 1
    v_mov_b32 v66, s42
    buffer_store_dword v66, v8, s[48:51], 0 offen sc1
L_fin_noep:
    s_mov_b64 exec, -1
    s_branch L_end
L_T:
    s_mul_i32 s40, s45, 7
    s_add_u32 s40, s40, 6
    s_mov_b32 s52, s24
    s_mov_b32 s53, s25
    s_mov_b32 s54, 4194304
    s_mov_b32 s55, 0x20000
    s_mov_b32 s56, s26
    s_mov_b32 s57, s27
    s_mov_b32 s58, 4718592
    s_mov_b32 s59, 0x20000
    s_lshl_b32 s71, s70, 1
    s_add_u32 s71, s71, s67
    s_lshl_b32 s71, s71, 1
    s_add_u32 s71, s71, s69
    s_lshl_b32 s71, s71, 10
    s_add_u32 s71, s71, 16384
    s_lshl_b32 s72, s70, 2
    s_add_u32 s72, s72, s67
    s_lshl_b32 s72, s72, 16
    s_lshl_b32 s73, s47, 8
    s_lshl_b32 s74, s69, 7
    s_add_u32 s73, s73, s74
    s_add_u32 s72, s72, s73
    s_mov_b32 m0, s71
    s_add_u32 s74, s72, 0
    buffer_load_dwordx4 v12, s[52:55], s74 offen nt lds
    s_add_u32 s71, s71, 8192
    s_mov_b32 m0, s71
    s_add_u32 s74, s72, 524288
    buffer_load_dwordx4 v12, s[52:55], s74 offen nt lds
    s_add_u32 s71, s71, 8192
    s_mov_b32 m0, s71
    s_add_u32 s74, s72, 131072
    buffer_load_dwordx4 v12, s[52:55], s74 offen nt lds
    s_add_u32 s71, s71, 8192
    s_mov_b32 m0, s71
    s_add_u32 s74, s72, 655360
    buffer_load_dwordx4 v12, s[52:55], s74 offen nt lds
    s_add_u32 s71, s71, 8192
    s_mov_b32 m0, s71
    s_add_u32 s74, s72, 1048576
    buffer_load_dwordx4 v12, s[52:55], s74 offen nt lds
    s_add_u32 s71, s71, 8192
    s_mov_b32 m0, s71
    s_add_u32 s74, s72, 1572864
    buffer_load_dwordx4 v12, s[52:55], s74 offen nt lds
    s_add_u32 s71, s71, 8192
    s_mov_b32 m0, s71
    s_add_u32 s74, s72, 1179648
    buffer_load_dwordx4 v12, s[52:55], s74 offen nt lds
    s_add_u32 s71, s71, 8192
    s_mov_b32 m0, s71
    s_add_u32 s74, s72, 1703936
    buffer_load_dwordx4 v12, s[52:55], s74 offen nt lds
    s_add_u32 s71, s71, 8192
    s_mov_b32 m0, s71
    s_add_u32 s74, s72, 2097152
    buffer_load_dwordx4 v12, s[52:55], s74 offen nt lds
    s_add_u32 s71, s71, 8192
    s_mov_b32 m0, s71
    s_add_u32 s74, s72, 2621440
    buffer_load_dwordx4 v12, s[52:55], s74 offen nt lds
    s_add_u32 s71, s71, 8192
    s_mov_b32 m0, s71
    s_add_u32 s74, s72, 2228224
    buffer_load_dwordx4 v12, s[52:55], s74 offen nt lds
    s_add_u32 s71, s71, 8192
    s_mov_b32 m0, s71
    s_add_u32 s74, s72, 2752512
    buffer_load_dwordx4 v12, s[52:55], s74 offen nt lds
    s_add_u32 s71, s71, 8192
    s_mov_b32 m0, s71
    s_add_u32 s74, s72, 3145728
    buffer_load_dwordx4 v12, s[52:55], s74 offen nt lds
    s_add_u32 s71, s71, 8192
    s_mov_b32 m0, s71
    s_add_u32 s74, s72, 3670016
    buffer_load_dwordx4 v12, s[52:55], s74 offen nt lds
    s_add_u32 s71, s71, 8192
    s_mov_b32 m0, s71
    s_add_u32 s74, s72, 3276800
    buffer_load_dwordx4 v12, s[52:55], s74 offen nt lds
    s_add_u32 s71, s71, 8192
    s_mov_b32 m0, s71
    s_add_u32 s74, s72, 3801088
    buffer_load_dwordx4 v12, s[52:55], s74 offen nt lds
    s_add_u32 s71, s71, 8192
    v_mul_u32_u24 v14, 1152, v2
    v_add_u32 v14, v14, v11
    s_mul_i32 s66, s47, 147456
    s_lshl_b32 s71, s68, 2
    s_add_u32 s71, s71, s67
    s_mul_i32 s72, s71, 9216
    s_add_u32 s72, s72, s66
    s_add_u32 s72, s72, 1024
    s_lshl_b32 s71, s71, 10
    s_add_u32 s71, s71, 147456
    s_mov_b32 m0, s71
    s_add_u32 s71, s71, 2048
    buffer_load_dwordx4 v14, s[56:59], s72 offen nt lds
    s_add_u32 s72, s72, 18432
    s_mov_b32 m0, s71
    s_nop 0
    buffer_load_dwordx4 v14, s[56:59], s72 offen nt lds
    s_mul_i32 s72, s44, 9216
    s_add_u32 s72, s72, s66
    s_barrier
    buffer_load_dwordx4 v[176:179], v14, s[56:59], s72 offen offset:0 nt
    buffer_load_dwordx4 v[180:183], v14, s[56:59], s72 offen offset:128 nt
    buffer_load_dwordx4 v[184:187], v14, s[56:59], s72 offen offset:256 nt
    buffer_load_dwordx4 v[188:191], v14, s[56:59], s72 offen offset:384 nt
    buffer_load_dwordx4 v[192:195], v14, s[56:59], s72 offen offset:512 nt
    buffer_load_dwordx4 v[196:199], v14, s[56:59], s72 offen offset:640 nt
    buffer_load_dwordx4 v[200:203], v14, s[56:59], s72 offen offset:768 nt
    buffer_load_dwordx4 v[204:207], v14, s[56:59], s72 offen offset:896 nt
    v_add_u32 v17, 0x10000, v16
    s_waitcnt vmcnt(10)
    s_barrier
    ds_read_b64_tr_b16 v[32:33], v16 offset:0
    ds_read_b64_tr_b16 v[34:35], v16 offset:512
    ds_read_b64_tr_b16 v[36:37], v16 offset:8192
    ds_read_b64_tr_b16 v[38:39], v16 offset:8704
    ds_read_b64_tr_b16 v[40:41], v16 offset:16384
    ds_read_b64_tr_b16 v[42:43], v16 offset:16896
    ds_read_b64_tr_b16 v[44:45], v16 offset:24576
    ds_read_b64_tr_b16 v[46:47], v16 offset:25088
    ds_read_b64_tr_b16 v[48:49], v16 offset:32768
    ds_read_b64_tr_b16 v[50:51], v16 offset:33280
    ds_read_b64_tr_b16 v[52:53], v16 offset:40960
    ds_read_b64_tr_b16 v[54:55], v16 offset:41472
    s_waitcnt lgkmcnt(4)
    ds_read_b64_tr_b16 v[56:57], v16 offset:49152
    ds_read_b64_tr_b16 v[58:59], v16 offset:49664
    ds_read_b64_tr_b16 v[60:61], v16 offset:57344
    ds_read_b64_tr_b16 v[62:63], v16 offset:57856
    ds_read_b64_tr_b16 v[64:65], v17 offset:0
    ds_read_b64_tr_b16 v[66:67], v17 offset:512
    ds_read_b64_tr_b16 v[68:69], v17 offset:8192
    ds_read_b64_tr_b16 v[70:71], v17 offset:8704
    ds_read_b64_tr_b16 v[72:73], v17 offset:16384
    ds_read_b64_tr_b16 v[74:75], v17 offset:16896
    ds_read_b64_tr_b16 v[76:77], v17 offset:24576
    ds_read_b64_tr_b16 v[78:79], v17 offset:25088
    s_waitcnt lgkmcnt(4)
    ds_read_b64_tr_b16 v[80:81], v17 offset:32768
    ds_read_b64_tr_b16 v[82:83], v17 offset:33280
    ds_read_b64_tr_b16 v[84:85], v17 offset:40960
    ds_read_b64_tr_b16 v[86:87], v17 offset:41472
    ds_read_b64_tr_b16 v[88:89], v17 offset:49152
    ds_read_b64_tr_b16 v[90:91], v17 offset:49664
    ds_read_b64_tr_b16 v[92:93], v17 offset:57344
    ds_read_b64_tr_b16 v[94:95], v17 offset:57856
    s_lshl_b32 s71, s67, 3
    s_add_u32 s71, s71, s68
    s_lshl_b32 s71, s71, 10
    s_add_u32 s71, s71, 16384
    v_add_u32 v19, s71, v9
    s_add_u32 s71, s71, 65536
    s_waitcnt lgkmcnt(0)
    s_barrier
    s_add_u32 s73, s66, 73728
    s_lshl_b32 s71, s44, 13
    s_add_u32 s71, s71, 16384
    v_add_u32 v19, s71, v9
    s_mul_i32 s72, s44, 9216
    s_add_u32 s72, s72, s73
    s_lshl_b32 s71, s44, 13
    s_add_u32 s71, s71, 81920
    s_add_u32 m0, s71, 0
    s_add_u32 s74, s72, 0
    buffer_load_dwordx4 v14, s[56:59], s74 offen nt lds
    s_add_u32 m0, s71, 1024
    s_add_u32 s74, s72, 128
    buffer_load_dwordx4 v14, s[56:59], s74 offen nt lds
    s_add_u32 m0, s71, 2048
    s_add_u32 s74, s72, 256
    buffer_load_dwordx4 v14, s[56:59], s74 offen nt lds
    s_add_u32 m0, s71, 3072
    s_add_u32 s74, s72, 384
    buffer_load_dwordx4 v14, s[56:59], s74 offen nt lds
    s_add_u32 m0, s71, 4096
    s_add_u32 s74, s72, 512
    buffer_load_dwordx4 v14, s[56:59], s74 offen nt lds
    s_add_u32 m0, s71, 5120
    s_add_u32 s74, s72, 640
    buffer_load_dwordx4 v14, s[56:59], s74 offen nt lds
    s_add_u32 m0, s71, 6144
    s_add_u32 s74, s72, 768
    buffer_load_dwordx4 v14, s[56:59], s74 offen nt lds
    s_add_u32 m0, s71, 7168
    s_add_u32 s74, s72, 896
    buffer_load_dwordx4 v14, s[56:59], s74 offen nt lds
    s_waitcnt vmcnt(15)
    ds_write_b128 v19, v[176:179] offset:0
    s_waitcnt vmcnt(14)
    ds_write_b128 v19, v[180:183] offset:1024
    s_waitcnt vmcnt(13)
    ds_write_b128 v19, v[184:187] offset:2048
    s_waitcnt vmcnt(12)
    ds_write_b128 v19, v[188:191] offset:3072
    s_waitcnt vmcnt(11)
    ds_write_b128 v19, v[192:195] offset:4096
    s_waitcnt vmcnt(10)
    ds_write_b128 v19, v[196:199] offset:5120
    s_waitcnt vmcnt(9)
    ds_write_b128 v19, v[200:203] offset:6144
    s_waitcnt vmcnt(8)
    ds_write_b128 v19, v[204:207] offset:7168
    v_lshl_add_u32 v16, v4, 13, v15
    v_add_u32 v17, 0x10000, v16
    v_lshl_add_u32 v18, v4, 10, v13
    v_add_u32 v18, 147456, v18
    v_lshlrev_b32 v21, 11, v3
    v_xor_b32 v22, v3, v4
    v_lshlrev_b32 v22, 4, v22
    v_lshl_add_u32 v22, v2, 11, v22
    v_and_b32 v12, 1, v2
    v_lshl_or_b32 v12, v12, 2, v4
    v_lshrrev_b32 v14, 1, v3
    v_xor_b32 v12, v12, v14
    v_lshlrev_b32 v12, 4, v12
    v_lshl_add_u32 v12, v3, 7, v12
    v_lshlrev_b32 v14, 3, v3
    s_lshl_b32 s66, s47, 14
    s_add_u32 s66, s66, 1310720
    s_lshl_b32 s73, s44, 7
    s_add_u32 s73, s73, s66
    s_lshl_b32 s72, s40, 7
    s_add_u32 s72, s72, 2097152
    v_lshrrev_b32 v23, 1, v3
    v_mul_u32_u24 v23, 320, v23
    v_lshl_add_u32 v23, v4, 3, v23
    s_lshl_b32 s74, s44, 5
    v_add_u32 v23, s74, v23
    v_mul_u32_u24 v10, 320, v6
    v_lshl_add_u32 v10, v4, 4, v10
    s_mul_i32 s74, s44, 16384
    s_add_u32 s72, s72, s74
    v_mul_u32_u24 v20, 131072, v5
    v_lshl_add_u32 v20, v4, 5, v20
    v_lshl_add_u32 v20, v6, 3, v20
    v_lshlrev_b32 v232, 2, v1
    ds_write_b32 v232, v8 offset:15360
    v_mov_b32 v236, 7168
    v_cmp_eq_u32 vcc, 0, v5
    s_nop 1
    v_cndmask_b32 v232, v236, v10, vcc
    v_cmp_eq_u32 vcc, 1, v5
    s_nop 1
    v_cndmask_b32 v233, v236, v10, vcc
    v_cmp_eq_u32 vcc, 2, v5
    s_nop 1
    v_cndmask_b32 v234, v236, v10, vcc
    v_cmp_eq_u32 vcc, 3, v5
    s_nop 1
    v_cndmask_b32 v235, v236, v10, vcc
    v_min_u32 v238, 35, v1
    v_lshlrev_b32 v238, 7, v238
    s_mov_b32 s76, 65536
    v_mov_b32 v28, 0
    v_mov_b32 v29, 0
    s_cmp_lg_u32 s44, 0
    s_cbranch_scc1 L_te1
    buffer_load_dword v239, v238, s[48:51], s76 offen sc1
L_te1:
    buffer_load_dwordx4 v[24:27], v22, s[48:51], s73 offen sc1
    s_cmp_lg_u32 s44, 7
    s_cbranch_scc1 L_te2
    s_mov_b64 exec, 0xff
    buffer_load_dwordx2 v[28:29], v21, s[48:51], s66 offen offset:1024 sc1
    s_mov_b64 exec, -1
L_te2:
    s_waitcnt vmcnt(0) lgkmcnt(0)
    s_barrier
    ds_read_b64_tr_b16 v[96:97], v16 offset:0
    ds_read_b64_tr_b16 v[98:99], v16 offset:512
    ds_read_b64_tr_b16 v[100:101], v16 offset:32768
    ds_read_b64_tr_b16 v[102:103], v16 offset:33280
    ds_read_b64_tr_b16 v[104:105], v17 offset:0
    ds_read_b64_tr_b16 v[106:107], v17 offset:512
    ds_read_b64_tr_b16 v[108:109], v17 offset:32768
    ds_read_b64_tr_b16 v[110:111], v17 offset:33280
    ds_read_b64_tr_b16 v[112:113], v16 offset:2048
    ds_read_b64_tr_b16 v[114:115], v16 offset:2560
    ds_read_b64_tr_b16 v[116:117], v16 offset:34816
    ds_read_b64_tr_b16 v[118:119], v16 offset:35328
    s_waitcnt lgkmcnt(4)
    ds_read_b64_tr_b16 v[120:121], v17 offset:2048
    ds_read_b64_tr_b16 v[122:123], v17 offset:2560
    ds_read_b64_tr_b16 v[124:125], v17 offset:34816
    ds_read_b64_tr_b16 v[126:127], v17 offset:35328
    ds_read_b64_tr_b16 v[128:129], v16 offset:4096
    ds_read_b64_tr_b16 v[130:131], v16 offset:4608
    ds_read_b64_tr_b16 v[132:133], v16 offset:36864
    ds_read_b64_tr_b16 v[134:135], v16 offset:37376
    ds_read_b64_tr_b16 v[136:137], v17 offset:4096
    ds_read_b64_tr_b16 v[138:139], v17 offset:4608
    ds_read_b64_tr_b16 v[140:141], v17 offset:36864
    ds_read_b64_tr_b16 v[142:143], v17 offset:37376
    s_waitcnt lgkmcnt(4)
    ds_read_b64_tr_b16 v[144:145], v16 offset:6144
    ds_read_b64_tr_b16 v[146:147], v16 offset:6656
    ds_read_b64_tr_b16 v[148:149], v16 offset:38912
    ds_read_b64_tr_b16 v[150:151], v16 offset:39424
    ds_read_b64_tr_b16 v[152:153], v17 offset:6144
    ds_read_b64_tr_b16 v[154:155], v17 offset:6656
    ds_read_b64_tr_b16 v[156:157], v17 offset:38912
    ds_read_b64_tr_b16 v[158:159], v17 offset:39424
    s_waitcnt lgkmcnt(4)
    ds_read_b64_tr_b16 v[160:161], v18 offset:0
    ds_read_b64_tr_b16 v[162:163], v18 offset:512
    ds_read_b64_tr_b16 v[164:165], v18 offset:4096
    ds_read_b64_tr_b16 v[166:167], v18 offset:4608
    ds_read_b64_tr_b16 v[168:169], v18 offset:8192
    ds_read_b64_tr_b16 v[170:171], v18 offset:8704
    ds_read_b64_tr_b16 v[172:173], v18 offset:12288
    ds_read_b64_tr_b16 v[174:175], v18 offset:12800
    s_mov_b32 s77, 0
    s_cmp_lg_u32 s44, 0
    s_cbranch_scc1 L_tpd
L_tpp:
    v_cmp_ne_u32 vcc, s43, v239
    s_add_u32 s77, s77, 1
    s_cbranch_vccz L_tpd
    s_cmp_ge_u32 s77, 400000
    s_cbranch_scc1 L_tpd
    buffer_load_dword v239, v238, s[48:51], s76 offen sc1
    s_waitcnt vmcnt(0)
    s_branch L_tpp
L_tpd:
    s_mov_b32 s77, 0
    s_branch L_tchk
L_tpoll:
    buffer_load_dwordx4 v[24:27], v22, s[48:51], s73 offen sc1
    s_cmp_lg_u32 s44, 7
    s_cbranch_scc1 L_tns
    s_mov_b64 exec, 0xff
    buffer_load_dwordx2 v[28:29], v21, s[48:51], s66 offen offset:1024 sc1
    s_mov_b64 exec, -1
L_tns:
    s_add_u32 s77, s77, 1
    s_waitcnt vmcnt(0)
L_tchk:
    v_max3_u32 v30, v24, v25, v26
    v_max3_u32 v30, v30, v27, v28
    v_max_u32 v30, v30, v29
    v_cmp_eq_u32 vcc, -1, v30
    s_cmp_ge_u32 s77, 400000
    s_cbranch_scc1 L_tdone
    s_cbranch_vccnz L_tpoll
L_tdone:
    ds_write_b128 v7, v[24:27] offset:0
    s_cmp_lg_u32 s44, 7
    s_cbranch_scc1 L_tnw
    s_mov_b64 exec, 0xff
    ds_write_b64 v14, v[28:29] offset:10240
    s_mov_b64 exec, -1
L_tnw:
    s_waitcnt lgkmcnt(0)
    s_cmp_ge_u32 s45, 3
    s_cbranch_scc1 L_tnwb
    s_cmp_lg_u32 s44, 6
    s_cbranch_scc1 L_tnwb
    buffer_wbl2 sc1
L_tnwb:
    s_barrier
    ds_read_b64 v[28:29], v14 offset:10240
    ds_read_b128 v[176:179], v12 offset:0
    ds_read_b128 v[180:183], v12 offset:1024
    ds_read_b128 v[184:187], v12 offset:2048
    ds_read_b128 v[188:191], v12 offset:3072
    ds_read_b128 v[192:195], v12 offset:4096
    ds_read_b128 v[196:199], v12 offset:5120
    ds_read_b128 v[200:203], v12 offset:6144
    ds_read_b128 v[204:207], v12 offset:7168
    s_waitcnt lgkmcnt(7)
    v_mfma_f32_16x16x32_bf16 v[24:27], v[32:35], v[176:179], 0
    v_mfma_f32_16x16x32_bf16 v[208:211], v[36:39], v[176:179], 0
    v_max_f32_dpp v30, v28, v28 quad_perm:[1,0,3,2] row_mask:0xf bank_mask:0xf
    s_waitcnt lgkmcnt(6)
    v_mfma_f32_16x16x32_bf16 v[24:27], v[40:43], v[180:183], v[24:27]
    v_mfma_f32_16x16x32_bf16 v[208:211], v[44:47], v[180:183], v[208:211]
    v_sub_f32 v30, v28, v30
    s_waitcnt lgkmcnt(5)
    v_mfma_f32_16x16x32_bf16 v[24:27], v[48:51], v[184:187], v[24:27]
    v_mfma_f32_16x16x32_bf16 v[208:211], v[52:55], v[184:187], v[208:211]
    v_exp_f32 v30, v30
    s_waitcnt lgkmcnt(4)
    v_mfma_f32_16x16x32_bf16 v[24:27], v[56:59], v[188:191], v[24:27]
    v_mfma_f32_16x16x32_bf16 v[208:211], v[60:63], v[188:191], v[208:211]
    v_mul_f32 v31, v30, v29
    s_waitcnt lgkmcnt(3)
    v_mfma_f32_16x16x32_bf16 v[24:27], v[64:67], v[192:195], v[24:27]
    v_mfma_f32_16x16x32_bf16 v[208:211], v[68:71], v[192:195], v[208:211]
    v_add_f32_dpp v31, v31, v31 quad_perm:[1,0,3,2] row_mask:0xf bank_mask:0xf
    s_waitcnt lgkmcnt(2)
    v_mfma_f32_16x16x32_bf16 v[24:27], v[72:75], v[196:199], v[24:27]
    v_mfma_f32_16x16x32_bf16 v[208:211], v[76:79], v[196:199], v[208:211]
    v_rcp_f32 v31, v31
    s_waitcnt lgkmcnt(1)
    v_mfma_f32_16x16x32_bf16 v[24:27], v[80:83], v[200:203], v[24:27]
    v_mfma_f32_16x16x32_bf16 v[208:211], v[84:87], v[200:203], v[208:211]
    v_mul_f32 v30, v30, v31
    s_waitcnt lgkmcnt(0)
    v_mfma_f32_16x16x32_bf16 v[24:27], v[88:91], v[204:207], v[24:27]
    v_mfma_f32_16x16x32_bf16 v[208:211], v[92:95], v[204:207], v[208:211]
    s_nop 7
    v_add_f32_dpp v24, v208, v24 row_ror:8 row_mask:0xf bank_mask:0xf
    v_add_f32_dpp v25, v209, v25 row_ror:8 row_mask:0xf bank_mask:0xf
    v_add_f32_dpp v26, v210, v26 row_ror:8 row_mask:0xf bank_mask:0xf
    v_add_f32_dpp v27, v211, v27 row_ror:8 row_mask:0xf bank_mask:0xf
    v_mul_f32 v24, v24, v30
    v_mul_f32 v25, v25, v30
    v_mul_f32 v26, v26, v30
    v_mul_f32 v27, v27, v30
    v_add_f32_dpp v24, v24, v24 quad_perm:[1,0,3,2] row_mask:0xf bank_mask:0xf
    v_add_f32_dpp v25, v25, v25 quad_perm:[1,0,3,2] row_mask:0xf bank_mask:0xf
    v_add_f32_dpp v26, v26, v26 quad_perm:[1,0,3,2] row_mask:0xf bank_mask:0xf
    v_add_f32_dpp v27, v27, v27 quad_perm:[1,0,3,2] row_mask:0xf bank_mask:0xf
    v_cvt_pk_bf16_f32 v28, v24, v25
    v_cvt_pk_bf16_f32 v29, v26, v27
    s_mov_b32 exec_lo, 0x00550055
    s_mov_b32 exec_hi, 0x00550055
    ds_write_b64 v23, v[28:29] offset:8192
    s_mov_b64 exec, -1
    s_waitcnt lgkmcnt(0)
L_tnouv:
    s_barrier
    ds_read_b128 v[176:179], v233 offset:8192
    ds_read_b128 v[180:183], v233 offset:8256
    ds_read_b128 v[184:187], v233 offset:8320
    ds_read_b128 v[188:191], v233 offset:8384
    ds_read_b128 v[192:195], v234 offset:8192
    ds_read_b128 v[196:199], v234 offset:8256
    ds_read_b128 v[200:203], v234 offset:8320
    ds_read_b128 v[204:207], v234 offset:8384
    s_add_u32 s74, s72, 524288
    s_cmp_lg_u32 s70, 0
    s_waitcnt lgkmcnt(7)
    v_mfma_f32_16x16x32_bf16 v[240:243], v[112:115], v[176:179], 0
    ds_read_b128 v[176:179], v235 offset:8192
    s_waitcnt lgkmcnt(7)
    v_mfma_f32_16x16x32_bf16 v[240:243], v[116:119], v[180:183], v[240:243]
    ds_read_b128 v[180:183], v235 offset:8256
    s_waitcnt lgkmcnt(7)
    v_mfma_f32_16x16x32_bf16 v[240:243], v[120:123], v[184:187], v[240:243]
    ds_read_b128 v[184:187], v235 offset:8320
    s_waitcnt lgkmcnt(7)
    v_mfma_f32_16x16x32_bf16 v[240:243], v[124:127], v[188:191], v[240:243]
    ds_read_b128 v[188:191], v235 offset:8384
    s_waitcnt lgkmcnt(7)
    v_mfma_f32_16x16x32_bf16 v[240:243], v[128:131], v[192:195], v[240:243]
    ds_read_b128 v[192:195], v232 offset:8192
    s_waitcnt lgkmcnt(7)
    v_mfma_f32_16x16x32_bf16 v[240:243], v[132:135], v[196:199], v[240:243]
    ds_read_b128 v[196:199], v232 offset:8256
    s_waitcnt lgkmcnt(7)
    v_mfma_f32_16x16x32_bf16 v[240:243], v[136:139], v[200:203], v[240:243]
    ds_read_b128 v[200:203], v232 offset:8320
    s_waitcnt lgkmcnt(7)
    v_mfma_f32_16x16x32_bf16 v[240:243], v[140:143], v[204:207], v[240:243]
    ds_read_b128 v[204:207], v232 offset:8384
    s_waitcnt lgkmcnt(7)
    v_mfma_f32_16x16x32_bf16 v[240:243], v[144:147], v[176:179], v[240:243]
    s_waitcnt lgkmcnt(6)
    v_mfma_f32_16x16x32_bf16 v[240:243], v[148:151], v[180:183], v[240:243]
    s_waitcnt lgkmcnt(5)
    v_mfma_f32_16x16x32_bf16 v[240:243], v[152:155], v[184:187], v[240:243]
    s_waitcnt lgkmcnt(4)
    v_mfma_f32_16x16x32_bf16 v[240:243], v[156:159], v[188:191], v[240:243]
    s_waitcnt lgkmcnt(3)
    v_mfma_f32_16x16x32_bf16 v[240:243], v[96:99], v[192:195], v[240:243]
    s_waitcnt lgkmcnt(2)
    v_mfma_f32_16x16x32_bf16 v[240:243], v[100:103], v[196:199], v[240:243]
    s_waitcnt lgkmcnt(1)
    v_mfma_f32_16x16x32_bf16 v[240:243], v[104:107], v[200:203], v[240:243]
    s_waitcnt lgkmcnt(0)
    v_mfma_f32_16x16x32_bf16 v[240:243], v[108:111], v[204:207], v[240:243]
    s_cbranch_scc1 L_tg_a
    v_mfma_f32_16x16x32_bf16 v[244:247], v[160:163], v[192:195], 0
    v_mfma_f32_16x16x32_bf16 v[244:247], v[164:167], v[196:199], v[244:247]
    v_mfma_f32_16x16x32_bf16 v[244:247], v[168:171], v[200:203], v[244:247]
    v_mfma_f32_16x16x32_bf16 v[244:247], v[172:175], v[204:207], v[244:247]
    s_nop 2
    v_cvt_pk_bf16_f32 v240, v240, v241
    v_cvt_pk_bf16_f32 v241, v242, v243
    buffer_store_dwordx2 v[240:241], v20, s[48:51], s72 offen sc1
    s_nop 1
    v_cvt_pk_bf16_f32 v244, v244, v245
    v_cvt_pk_bf16_f32 v245, v246, v247
    s_mov_b64 exec, s[78:79]
    buffer_store_dwordx2 v[244:245], v20, s[48:51], s74 offen sc1
    s_mov_b64 exec, -1
    s_branch L_tg_b
L_tg_a:
    s_nop 6
    v_cvt_pk_bf16_f32 v240, v240, v241
    v_cvt_pk_bf16_f32 v241, v242, v243
    buffer_store_dwordx2 v[240:241], v20, s[48:51], s72 offen sc1
L_tg_b:
    s_branch L_end
L_F:
    s_cmp_lt_u32 s64, 2
    s_cselect_b64 vcc, -1, 0
    s_and_b32 s74, s76, 7
    s_cmp_eq_u32 s74, 3
    s_cselect_b64 vcc, -1, vcc
    s_mov_b32 m0, s71
    s_add_u32 s71, s71, 8192
    buffer_load_dwordx4 v12, s[60:63], s72 offen nt lds
    s_add_u32 s72, s72, 294912
    s_cbranch_vccnz L_fw0
    s_waitcnt vmcnt(2)
L_fw0:
    s_mov_b32 m0, s71
    s_add_u32 s71, s71, 8192
    buffer_load_dwordx4 v12, s[60:63], s72 offen nt lds
    s_add_u32 s72, s72, 294912
    s_cbranch_vccnz L_fw1
    s_waitcnt vmcnt(2)
L_fw1:
    s_mov_b32 m0, s71
    s_add_u32 s71, s71, 8192
    buffer_load_dwordx4 v12, s[60:63], s72 offen nt lds
    s_add_u32 s72, s72, 294912
    s_cbranch_vccnz L_fw2
    s_waitcnt vmcnt(2)
L_fw2:
    s_mov_b32 m0, s71
    s_add_u32 s71, s71, 8192
    buffer_load_dwordx4 v12, s[60:63], s72 offen nt lds
    s_add_u32 s72, s72, 294912
    s_cbranch_vccnz L_fw3
    s_waitcnt vmcnt(2)
L_fw3:
    s_mov_b32 m0, s71
    s_add_u32 s71, s71, 8192
    buffer_load_dwordx4 v12, s[60:63], s72 offen nt lds
    s_add_u32 s72, s72, 294912
    s_cbranch_vccnz L_fw4
    s_waitcnt vmcnt(2)
L_fw4:
    s_mov_b32 m0, s71
    s_add_u32 s71, s71, 8192
    buffer_load_dwordx4 v12, s[60:63], s72 offen nt lds
    s_add_u32 s72, s72, 294912
    s_cbranch_vccnz L_fw5
    s_waitcnt vmcnt(2)
L_fw5:
    s_mov_b32 m0, s71
    s_add_u32 s71, s71, 8192
    buffer_load_dwordx4 v12, s[60:63], s72 offen nt lds
    s_add_u32 s72, s72, 294912
    s_mov_b32 m0, s71
    s_add_u32 s71, s71, 8192
    buffer_load_dwordx4 v12, s[60:63], s72 offen nt lds
    s_add_u32 s72, s72, 294912
    s_mov_b32 m0, s71
    s_add_u32 s71, s71, 8192
    buffer_load_dwordx4 v12, s[60:63], s72 offen nt lds
    s_add_u32 s72, s72, 294912
    ds_read_b128 v[32:35], v18 offset:0
    ds_read_b128 v[36:39], v18 offset:64
    ds_read_b128 v[40:43], v18 offset:128
    ds_read_b128 v[44:47], v18 offset:192
    ds_read_b128 v[48:51], v18 offset:256
    ds_read_b128 v[52:55], v18 offset:320
    ds_read_b128 v[56:59], v18 offset:384
    ds_read_b128 v[60:63], v18 offset:448
    ds_read_b128 v[64:67], v18 offset:512
    ds_read_b128 v[68:71], v18 offset:576
    ds_read_b128 v[72:75], v18 offset:640
    ds_read_b128 v[76:79], v18 offset:704
    s_waitcnt lgkmcnt(4)
    ds_read_b128 v[80:83], v18 offset:768
    ds_read_b128 v[84:87], v18 offset:832
    ds_read_b128 v[88:91], v18 offset:896
    ds_read_b128 v[92:95], v18 offset:960
    ds_read_b128 v[96:99], v18 offset:1024
    ds_read_b128 v[100:103], v18 offset:1088
    s_barrier
    s_mov_b32 m0, s71
    s_add_u32 s71, s71, 8192
    buffer_load_dwordx4 v12, s[60:63], s72 offen nt lds
    s_add_u32 s72, s72, 294912
    s_mov_b32 m0, s71
    s_add_u32 s71, s71, 8192
    buffer_load_dwordx4 v12, s[60:63], s72 offen nt lds
    s_add_u32 s72, s72, 294912
    s_mov_b32 m0, s71
    s_add_u32 s71, s71, 8192
    buffer_load_dwordx4 v12, s[60:63], s72 offen nt lds
    s_add_u32 s72, s72, 294912
    s_mov_b32 m0, s71
    s_add_u32 s71, s71, 8192
    buffer_load_dwordx4 v12, s[60:63], s72 offen nt lds
    s_add_u32 s72, s72, 294912
    s_mov_b32 m0, s71
    s_add_u32 s71, s71, 8192
    buffer_load_dwordx4 v12, s[60:63], s72 offen nt lds
    s_add_u32 s72, s72, 294912
    s_mov_b32 m0, s71
    s_add_u32 s71, s71, 8192
    buffer_load_dwordx4 v12, s[60:63], s72 offen nt lds
    s_add_u32 s72, s72, 294912
    s_mov_b32 m0, s71
    s_add_u32 s71, s71, 8192
    buffer_load_dwordx4 v12, s[60:63], s72 offen nt lds
    s_add_u32 s72, s72, 294912
    s_mov_b32 m0, s71
    s_add_u32 s71, s71, 8192
    buffer_load_dwordx4 v12, s[60:63], s72 offen nt lds
    s_add_u32 s72, s72, 294912
    s_mov_b32 m0, s71
    s_add_u32 s71, s71, 8192
    buffer_load_dwordx4 v12, s[60:63], s72 offen nt lds
    s_add_u32 s72, s72, 294912
    s_mov_b32 s56, s34
    s_mov_b32 s57, s35
    s_mov_b32 s58, 5308416
    s_mov_b32 s59, 0x20000
    v_mul_u32_u24 v14, 1152, v2
    v_add_u32 v14, v14, v11
    v_lshrrev_b32 v19, 1, v6
    v_lshrrev_b32 v21, 1, v5
    v_and_b32 v22, 1, v4
    v_lshl_or_b32 v21, v22, 1, v21
    v_lshl_or_b32 v21, v19, 2, v21
    v_xor_b32 v21, s44, v21
    v_lshlrev_b32 v21, 4, v21
    v_lshl_add_u32 v21, v5, 7, v21
    v_and_b32 v22, 1, v6
    v_lshl_add_u32 v21, v22, 3, v21
    v_lshl_add_u32 v21, v19, 10, v21
    v_lshl_add_u32 v21, v4, 11, v21
    v_add_u32 v21, 16384, v21
    v_add_u32 v22, 65536, v21
    v_add_u32 v23, 131072, v21
    s_mul_i32 s73, s76, 73728
    s_lshl_b32 s71, s67, 3
    s_add_u32 s71, s71, s68
    s_lshl_b32 s71, s71, 10
    s_add_u32 s71, s71, 16384
    s_mul_i32 s72, s67, 9216
    s_lshl_b32 s74, s68, 7
    s_add_u32 s72, s72, s74
    s_add_u32 s72, s72, s73
    v_min_u32 v140, 35, v1
    v_lshlrev_b32 v140, 7, v140
    s_mov_b32 s66, 65536
    s_waitcnt vmcnt(9) lgkmcnt(0)
    s_barrier
    ds_read_b64_tr_b16 v[104:105], v21 offset:0
    ds_read_b64_tr_b16 v[106:107], v21 offset:512
    ds_read_b64_tr_b16 v[108:109], v21 offset:8192
    ds_read_b64_tr_b16 v[110:111], v21 offset:8704
    ds_read_b64_tr_b16 v[112:113], v21 offset:16384
    ds_read_b64_tr_b16 v[114:115], v21 offset:16896
    ds_read_b64_tr_b16 v[116:117], v21 offset:24576
    ds_read_b64_tr_b16 v[118:119], v21 offset:25088
    ds_read_b64_tr_b16 v[120:121], v21 offset:32768
    ds_read_b64_tr_b16 v[122:123], v21 offset:33280
    ds_read_b64_tr_b16 v[124:125], v21 offset:40960
    ds_read_b64_tr_b16 v[126:127], v21 offset:41472
    s_waitcnt lgkmcnt(10)
    v_mfma_f32_16x16x32_bf16 v[28:31], v[104:107], v[32:35], 0
    ds_read_b64_tr_b16 v[128:129], v21 offset:49152
    ds_read_b64_tr_b16 v[130:131], v21 offset:49664
    s_waitcnt lgkmcnt(10)
    v_mfma_f32_16x16x32_bf16 v[28:31], v[108:111], v[36:39], v[28:31]
    ds_read_b64_tr_b16 v[132:133], v21 offset:57344
    ds_read_b64_tr_b16 v[134:135], v21 offset:57856
    s_waitcnt lgkmcnt(10)
    v_mfma_f32_16x16x32_bf16 v[28:31], v[112:115], v[40:43], v[28:31]
    ds_read_b64_tr_b16 v[104:105], v22 offset:0
    ds_read_b64_tr_b16 v[106:107], v22 offset:512
    s_waitcnt lgkmcnt(10)
    v_mfma_f32_16x16x32_bf16 v[28:31], v[116:119], v[44:47], v[28:31]
    s_waitcnt lgkmcnt(8)
    v_mfma_f32_16x16x32_bf16 v[28:31], v[120:123], v[48:51], v[28:31]
    s_waitcnt lgkmcnt(6)
    v_mfma_f32_16x16x32_bf16 v[28:31], v[124:127], v[52:55], v[28:31]
    s_waitcnt lgkmcnt(4)
    v_mfma_f32_16x16x32_bf16 v[28:31], v[128:131], v[56:59], v[28:31]
    s_waitcnt lgkmcnt(2)
    v_mfma_f32_16x16x32_bf16 v[28:31], v[132:135], v[60:63], v[28:31]
    s_waitcnt lgkmcnt(0)
    v_mfma_f32_16x16x32_bf16 v[28:31], v[104:107], v[64:67], v[28:31]
    s_barrier
    s_cmp_lg_u32 s44, 7
    s_cbranch_scc1 L_f_np
    buffer_load_dword v141, v140, s[48:51], s66 offen sc1
L_f_np:
    s_mul_i32 s72, s44, 9216
    s_add_u32 s72, s72, s73
    s_lshl_b32 s71, s44, 13
    s_add_u32 s71, s71, 16384
    s_add_u32 m0, s71, 0
    s_add_u32 s74, s72, 0
    buffer_load_dwordx4 v14, s[56:59], s74 offen nt lds
    s_add_u32 m0, s71, 1024
    s_add_u32 s74, s72, 128
    buffer_load_dwordx4 v14, s[56:59], s74 offen nt lds
    s_add_u32 m0, s71, 2048
    s_add_u32 s74, s72, 256
    buffer_load_dwordx4 v14, s[56:59], s74 offen nt lds
    s_add_u32 m0, s71, 3072
    s_add_u32 s74, s72, 384
    buffer_load_dwordx4 v14, s[56:59], s74 offen nt lds
    s_add_u32 m0, s71, 4096
    s_add_u32 s74, s72, 512
    buffer_load_dwordx4 v14, s[56:59], s74 offen nt lds
    s_add_u32 m0, s71, 5120
    s_add_u32 s74, s72, 640
    buffer_load_dwordx4 v14, s[56:59], s74 offen nt lds
    s_add_u32 m0, s71, 6144
    s_add_u32 s74, s72, 768
    buffer_load_dwordx4 v14, s[56:59], s74 offen nt lds
    s_add_u32 m0, s71, 7168
    s_add_u32 s74, s72, 896
    buffer_load_dwordx4 v14, s[56:59], s74 offen nt lds
    s_mul_i32 s72, s44, 9216
    s_add_u32 s72, s72, s73
    s_add_u32 s72, s72, 1024
    s_lshl_b32 s71, s44, 10
    s_add_u32 s71, s71, 81920
    s_mov_b32 m0, s71
    s_nop 0
    buffer_load_dwordx4 v14, s[56:59], s72 offen nt lds
    s_waitcnt vmcnt(9)
    s_barrier
    ds_read_b64_tr_b16 v[108:109], v22 offset:8192
    ds_read_b64_tr_b16 v[110:111], v22 offset:8704
    ds_read_b64_tr_b16 v[112:113], v22 offset:16384
    ds_read_b64_tr_b16 v[114:115], v22 offset:16896
    ds_read_b64_tr_b16 v[116:117], v22 offset:24576
    ds_read_b64_tr_b16 v[118:119], v22 offset:25088
    ds_read_b64_tr_b16 v[120:121], v22 offset:32768
    ds_read_b64_tr_b16 v[122:123], v22 offset:33280
    ds_read_b64_tr_b16 v[124:125], v22 offset:40960
    ds_read_b64_tr_b16 v[126:127], v22 offset:41472
    ds_read_b64_tr_b16 v[128:129], v22 offset:49152
    ds_read_b64_tr_b16 v[130:131], v22 offset:49664
    s_waitcnt lgkmcnt(10)
    v_mfma_f32_16x16x32_bf16 v[28:31], v[108:111], v[68:71], v[28:31]
    ds_read_b64_tr_b16 v[132:133], v22 offset:57344
    ds_read_b64_tr_b16 v[134:135], v22 offset:57856
    s_waitcnt lgkmcnt(10)
    v_mfma_f32_16x16x32_bf16 v[28:31], v[112:115], v[72:75], v[28:31]
    ds_read_b64_tr_b16 v[104:105], v23 offset:0
    ds_read_b64_tr_b16 v[106:107], v23 offset:512
    s_waitcnt lgkmcnt(10)
    v_mfma_f32_16x16x32_bf16 v[28:31], v[116:119], v[76:79], v[28:31]
    ds_read_b64_tr_b16 v[108:109], v23 offset:8192
    ds_read_b64_tr_b16 v[110:111], v23 offset:8704
    s_waitcnt lgkmcnt(10)
    v_mfma_f32_16x16x32_bf16 v[28:31], v[120:123], v[80:83], v[28:31]
    s_waitcnt lgkmcnt(8)
    v_mfma_f32_16x16x32_bf16 v[28:31], v[124:127], v[84:87], v[28:31]
    s_waitcnt lgkmcnt(6)
    v_mfma_f32_16x16x32_bf16 v[28:31], v[128:131], v[88:91], v[28:31]
    s_waitcnt lgkmcnt(4)
    v_mfma_f32_16x16x32_bf16 v[28:31], v[132:135], v[92:95], v[28:31]
    s_waitcnt lgkmcnt(2)
    v_mfma_f32_16x16x32_bf16 v[28:31], v[104:107], v[96:99], v[28:31]
    s_waitcnt lgkmcnt(0)
    v_mfma_f32_16x16x32_bf16 v[28:31], v[108:111], v[100:103], v[28:31]
    v_lshl_add_u32 v16, v4, 13, v15
    v_add_u32 v17, 0x10000, v16
    v_lshl_add_u32 v18, v4, 10, v13
    v_add_u32 v18, 81920, v18
    s_lshl_b32 s72, s76, 7
    s_add_u32 s72, s72, 2104320
    s_mul_i32 s74, s44, 16384
    s_add_u32 s72, s72, s74
    v_mul_u32_u24 v20, 131072, v5
    v_lshl_add_u32 v20, v4, 5, v20
    v_lshl_add_u32 v20, v6, 3, v20
    v_lshlrev_b32 v232, 2, v1
    ds_write_b32 v232, v8 offset:15360
    v_mul_u32_u24 v22, 192, v6
    v_lshl_add_u32 v21, v4, 3, v22
    s_lshl_b32 s74, s44, 4
    v_add_u32 v21, s74, v21
    v_lshl_add_u32 v22, v4, 4, v22
    v_mov_b32 v236, 5632
    v_cmp_eq_u32 vcc, 0, v5
    s_nop 1
    v_cndmask_b32 v232, v236, v22, vcc
    v_cmp_eq_u32 vcc, 1, v5
    s_nop 1
    v_cndmask_b32 v233, v236, v22, vcc
    v_cmp_eq_u32 vcc, 2, v5
    s_nop 1
    v_cndmask_b32 v234, v236, v22, vcc
    v_cmp_eq_u32 vcc, 3, v5
    s_nop 1
    v_cndmask_b32 v235, v236, v22, vcc
    v_mov_b32 v24, v28
    v_mov_b32 v25, v29
    v_mov_b32 v26, v30
    v_mov_b32 v27, v31
    v_permlane32_swap_b32 v28, v24
    v_permlane32_swap_b32 v29, v25
    v_permlane32_swap_b32 v30, v26
    v_permlane32_swap_b32 v31, v27
    s_mov_b32 s74, 0x3d372713
    s_mov_b32 s75, 0xc0135761
    v_cvt_pk_bf16_f32 v28, v28, v28
    v_lshlrev_b32 v28, 16, v28
    v_cvt_pk_bf16_f32 v24, v24, v24
    v_lshlrev_b32 v24, 16, v24
    v_cvt_pk_bf16_f32 v29, v29, v29
    v_lshlrev_b32 v29, 16, v29
    v_cvt_pk_bf16_f32 v25, v25, v25
    v_lshlrev_b32 v25, 16, v25
    v_cvt_pk_bf16_f32 v30, v30, v30
    v_lshlrev_b32 v30, 16, v30
    v_cvt_pk_bf16_f32 v26, v26, v26
    v_lshlrev_b32 v26, 16, v26
    v_cvt_pk_bf16_f32 v31, v31, v31
    v_lshlrev_b32 v31, 16, v31
    v_cvt_pk_bf16_f32 v27, v27, v27
    v_lshlrev_b32 v27, 16, v27
    v_mul_f32 v104, v28, v28
    v_mul_f32 v105, v29, v29
    v_mul_f32 v106, v30, v30
    v_mul_f32 v107, v31, v31
    v_fma_f32 v104, v104, s74, 1.0
    v_fma_f32 v105, v105, s74, 1.0
    v_fma_f32 v106, v106, s74, 1.0
    v_fma_f32 v107, v107, s74, 1.0
    v_mul_f32 v104, v104, v28
    v_mul_f32 v105, v105, v29
    v_mul_f32 v106, v106, v30
    v_mul_f32 v107, v107, v31
    v_mul_f32 v104, s75, v104
    v_mul_f32 v105, s75, v105
    v_mul_f32 v106, s75, v106
    v_mul_f32 v107, s75, v107
    v_exp_f32 v104, v104
    v_exp_f32 v105, v105
    v_exp_f32 v106, v106
    v_exp_f32 v107, v107
    v_add_f32 v104, 1.0, v104
    v_add_f32 v105, 1.0, v105
    v_add_f32 v106, 1.0, v106
    v_add_f32 v107, 1.0, v107
    v_rcp_f32 v104, v104
    v_rcp_f32 v105, v105
    v_rcp_f32 v106, v106
    v_rcp_f32 v107, v107
    v_mul_f32 v28, v28, v104
    v_mul_f32 v29, v29, v105
    v_mul_f32 v30, v30, v106
    v_mul_f32 v31, v31, v107
    v_cvt_pk_bf16_f32 v28, v28, v28
    v_lshlrev_b32 v28, 16, v28
    v_cvt_pk_bf16_f32 v29, v29, v29
    v_lshlrev_b32 v29, 16, v29
    v_cvt_pk_bf16_f32 v30, v30, v30
    v_lshlrev_b32 v30, 16, v30
    v_cvt_pk_bf16_f32 v31, v31, v31
    v_lshlrev_b32 v31, 16, v31
    v_mul_f32 v28, v28, v24
    v_mul_f32 v29, v29, v25
    v_mul_f32 v30, v30, v26
    v_mul_f32 v31, v31, v27
    v_cvt_pk_bf16_f32 v24, v28, v29
    v_cvt_pk_bf16_f32 v25, v30, v31
    s_mov_b64 exec, 0x000f000f
    ds_write_b64 v21, v[24:25] offset:9728
    s_mov_b64 exec, -1
    s_cmp_lg_u32 s44, 7
    s_cbranch_scc1 L_f_pd
    s_mov_b32 s77, 0
L_f_pp:
    v_cmp_ne_u32 vcc, s43, v141
    s_add_u32 s77, s77, 1
    s_cbranch_vccz L_f_pd
    s_cmp_ge_u32 s77, 400000
    s_cbranch_scc1 L_f_pd
    buffer_load_dword v141, v140, s[48:51], s66 offen sc1
    s_waitcnt vmcnt(0)
    s_branch L_f_pp
L_f_pd:
    s_waitcnt vmcnt(0) lgkmcnt(0)
    s_barrier
    ds_read_b64_tr_b16 v[144:145], v16 offset:0
    ds_read_b64_tr_b16 v[146:147], v16 offset:512
    ds_read_b64_tr_b16 v[148:149], v16 offset:32768
    ds_read_b64_tr_b16 v[150:151], v16 offset:33280
    ds_read_b64_tr_b16 v[152:153], v16 offset:2048
    ds_read_b64_tr_b16 v[154:155], v16 offset:2560
    ds_read_b64_tr_b16 v[156:157], v16 offset:34816
    ds_read_b64_tr_b16 v[158:159], v16 offset:35328
    ds_read_b64_tr_b16 v[160:161], v16 offset:4096
    ds_read_b64_tr_b16 v[162:163], v16 offset:4608
    ds_read_b64_tr_b16 v[164:165], v16 offset:36864
    ds_read_b64_tr_b16 v[166:167], v16 offset:37376
    s_waitcnt lgkmcnt(4)
    ds_read_b64_tr_b16 v[168:169], v16 offset:6144
    ds_read_b64_tr_b16 v[170:171], v16 offset:6656
    ds_read_b64_tr_b16 v[172:173], v16 offset:38912
    ds_read_b64_tr_b16 v[174:175], v16 offset:39424
    s_waitcnt lgkmcnt(4)
    ds_read_b64_tr_b16 v[176:177], v18 offset:0
    ds_read_b64_tr_b16 v[178:179], v18 offset:512
    ds_read_b64_tr_b16 v[180:181], v18 offset:4096
    ds_read_b64_tr_b16 v[182:183], v18 offset:4608
    s_waitcnt lgkmcnt(6)
    ds_read_b128 v[104:107], v233 offset:9728
    ds_read_b128 v[108:111], v233 offset:9792
    ds_read_b128 v[112:115], v234 offset:9728
    ds_read_b128 v[116:119], v234 offset:9792
    ds_read_b128 v[120:123], v235 offset:9728
    ds_read_b128 v[124:127], v235 offset:9792
    ds_read_b128 v[128:131], v232 offset:9728
    ds_read_b128 v[132:135], v232 offset:9792
    s_add_u32 s74, s72, 524288
    s_cmp_lg_u32 s70, 0
    s_waitcnt lgkmcnt(7)
    v_mfma_f32_16x16x32_bf16 v[240:243], v[152:155], v[104:107], 0
    s_waitcnt lgkmcnt(6)
    v_mfma_f32_16x16x32_bf16 v[240:243], v[156:159], v[108:111], v[240:243]
    s_waitcnt lgkmcnt(5)
    v_mfma_f32_16x16x32_bf16 v[240:243], v[160:163], v[112:115], v[240:243]
    s_waitcnt lgkmcnt(4)
    v_mfma_f32_16x16x32_bf16 v[240:243], v[164:167], v[116:119], v[240:243]
    s_waitcnt lgkmcnt(3)
    v_mfma_f32_16x16x32_bf16 v[240:243], v[168:171], v[120:123], v[240:243]
    s_waitcnt lgkmcnt(2)
    v_mfma_f32_16x16x32_bf16 v[240:243], v[172:175], v[124:127], v[240:243]
    s_waitcnt lgkmcnt(1)
    v_mfma_f32_16x16x32_bf16 v[240:243], v[144:147], v[128:131], v[240:243]
    s_waitcnt lgkmcnt(0)
    v_mfma_f32_16x16x32_bf16 v[240:243], v[148:151], v[132:135], v[240:243]
    s_cbranch_scc1 L_fg_a
    v_mfma_f32_16x16x32_bf16 v[244:247], v[176:179], v[128:131], 0
    v_mfma_f32_16x16x32_bf16 v[244:247], v[180:183], v[132:135], v[244:247]
    s_nop 4
    v_cvt_pk_bf16_f32 v240, v240, v241
    v_cvt_pk_bf16_f32 v241, v242, v243
    buffer_store_dwordx2 v[240:241], v20, s[48:51], s72 offen sc1
    v_cvt_pk_bf16_f32 v244, v244, v245
    v_cvt_pk_bf16_f32 v245, v246, v247
    s_mov_b64 exec, s[78:79]
    buffer_store_dwordx2 v[244:245], v20, s[48:51], s74 offen sc1
    s_mov_b64 exec, -1
    s_branch L_fg_b
L_fg_a:
    s_nop 6
    v_cvt_pk_bf16_f32 v240, v240, v241
    v_cvt_pk_bf16_f32 v241, v242, v243
    buffer_store_dwordx2 v[240:241], v20, s[48:51], s72 offen sc1
L_fg_b:
    s_branch L_end
L_att:
    s_mov_b64 exec, -1
    s_cmp_ge_u32 s44, 4
    s_cbranch_scc1 L_att_hi
    s_load_dwordx2 s[48:49], s[0:1], 96
    s_load_dwordx16 s[16:31], s[0:1], 0
    s_load_dwordx8 s[32:39], s[0:1], 64
    s_mov_b32 s50, 0x10000000
    s_mov_b32 s51, 0x20000
    s_mov_b32 s55, 0x20000
    v_lshrrev_b32 v2, 3, v1
    v_and_b32 v3, 7, v1
    v_lshrrev_b32 v4, 4, v1
    v_bfe_u32 v5, v1, 2, 2
    v_and_b32 v6, 3, v1
    v_lshlrev_b32 v7, 4, v0
    v_mov_b32 v8, 0
    s_waitcnt lgkmcnt(0)
    s_load_dword s42, s[48:49], 0
    s_lshl_b32 s70, s45, 4
    s_add_u32 s70, s70, s46
    s_lshl_b32 s66, s70, 17
    s_lshl_b32 s67, s44, 15
    s_add_u32 s66, s66, s67
    s_mov_b32 s52, s18
    s_mov_b32 s53, s19
    s_mov_b32 s54, 16777216
    s_mov_b32 s55, 0x20000
    s_waitcnt vmcnt(0)
    s_add_u32 m0, s67, 0
    s_add_u32 s69, s66, 0
    v_xor_b32 v10, 0, v9
    buffer_load_dwordx4 v10, s[52:55], s69 offen offset:0 nt lds
    v_xor_b32 v10, 64, v9
    buffer_load_dwordx4 v10, s[52:55], s69 offen offset:1024 nt lds
    v_xor_b32 v10, 128, v9
    buffer_load_dwordx4 v10, s[52:55], s69 offen offset:2048 nt lds
    v_xor_b32 v10, 192, v9
    buffer_load_dwordx4 v10, s[52:55], s69 offen offset:3072 nt lds
    s_add_u32 m0, s67, 4096
    s_add_u32 s69, s66, 4096
    v_xor_b32 v10, 16, v9
    buffer_load_dwordx4 v10, s[52:55], s69 offen offset:0 nt lds
    v_xor_b32 v10, 80, v9
    buffer_load_dwordx4 v10, s[52:55], s69 offen offset:1024 nt lds
    v_xor_b32 v10, 144, v9
    buffer_load_dwordx4 v10, s[52:55], s69 offen offset:2048 nt lds
    v_xor_b32 v10, 208, v9
    buffer_load_dwordx4 v10, s[52:55], s69 offen offset:3072 nt lds
    s_add_u32 m0, s67, 8192
    s_add_u32 s69, s66, 8192
    v_xor_b32 v10, 32, v9
    buffer_load_dwordx4 v10, s[52:55], s69 offen offset:0 nt lds
    v_xor_b32 v10, 96, v9
    buffer_load_dwordx4 v10, s[52:55], s69 offen offset:1024 nt lds
    v_xor_b32 v10, 160, v9
    buffer_load_dwordx4 v10, s[52:55], s69 offen offset:2048 nt lds
    v_xor_b32 v10, 224, v9
    buffer_load_dwordx4 v10, s[52:55], s69 offen offset:3072 nt lds
    s_add_u32 m0, s67, 12288
    s_add_u32 s69, s66, 12288
    v_xor_b32 v10, 48, v9
    buffer_load_dwordx4 v10, s[52:55], s69 offen offset:0 nt lds
    v_xor_b32 v10, 112, v9
    buffer_load_dwordx4 v10, s[52:55], s69 offen offset:1024 nt lds
    v_xor_b32 v10, 176, v9
    buffer_load_dwordx4 v10, s[52:55], s69 offen offset:2048 nt lds
    v_xor_b32 v10, 240, v9
    buffer_load_dwordx4 v10, s[52:55], s69 offen offset:3072 nt lds
    s_add_u32 m0, s67, 16384
    s_add_u32 s69, s66, 16384
    v_xor_b32 v10, 0, v9
    buffer_load_dwordx4 v10, s[52:55], s69 offen offset:0 nt lds
    v_xor_b32 v10, 64, v9
    buffer_load_dwordx4 v10, s[52:55], s69 offen offset:1024 nt lds
    v_xor_b32 v10, 128, v9
    buffer_load_dwordx4 v10, s[52:55], s69 offen offset:2048 nt lds
    v_xor_b32 v10, 192, v9
    buffer_load_dwordx4 v10, s[52:55], s69 offen offset:3072 nt lds
    s_add_u32 m0, s67, 20480
    s_add_u32 s69, s66, 20480
    v_xor_b32 v10, 16, v9
    buffer_load_dwordx4 v10, s[52:55], s69 offen offset:0 nt lds
    v_xor_b32 v10, 80, v9
    buffer_load_dwordx4 v10, s[52:55], s69 offen offset:1024 nt lds
    v_xor_b32 v10, 144, v9
    buffer_load_dwordx4 v10, s[52:55], s69 offen offset:2048 nt lds
    v_xor_b32 v10, 208, v9
    buffer_load_dwordx4 v10, s[52:55], s69 offen offset:3072 nt lds
    s_add_u32 m0, s67, 24576
    s_add_u32 s69, s66, 24576
    v_xor_b32 v10, 32, v9
    buffer_load_dwordx4 v10, s[52:55], s69 offen offset:0 nt lds
    v_xor_b32 v10, 96, v9
    buffer_load_dwordx4 v10, s[52:55], s69 offen offset:1024 nt lds
    v_xor_b32 v10, 160, v9
    buffer_load_dwordx4 v10, s[52:55], s69 offen offset:2048 nt lds
    v_xor_b32 v10, 224, v9
    buffer_load_dwordx4 v10, s[52:55], s69 offen offset:3072 nt lds
    s_add_u32 m0, s67, 28672
    s_add_u32 s69, s66, 28672
    v_xor_b32 v10, 48, v9
    buffer_load_dwordx4 v10, s[52:55], s69 offen offset:0 nt lds
    v_xor_b32 v10, 112, v9
    buffer_load_dwordx4 v10, s[52:55], s69 offen offset:1024 nt lds
    v_xor_b32 v10, 176, v9
    buffer_load_dwordx4 v10, s[52:55], s69 offen offset:2048 nt lds
    v_xor_b32 v10, 240, v9
    buffer_load_dwordx4 v10, s[52:55], s69 offen offset:3072 nt lds
    s_barrier
    v_and_b32 v11, 2, v1
    v_lshlrev_b32 v11, 1, v11
    v_or_b32 v11, v11, v5
    v_lshrrev_b32 v12, 5, v1
    v_xor_b32 v11, v11, v12
    v_lshlrev_b32 v11, 4, v11
    v_lshl_add_u32 v11, v3, 7, v11
    v_and_b32 v13, 3, v2
    v_lshl_add_u32 v11, v13, 13, v11
    v_add_u32 v20, 131072, v11
    v_lshl_or_b32 v11, v6, 2, v5
    v_xor_b32 v11, v11, v12
    v_lshlrev_b32 v11, 4, v11
    v_and_b32 v13, 31, v1
    v_lshl_add_u32 v11, v13, 10, v11
    v_add_u32 v120, s67, v11
    v_xor_b32 v21, 32, v20
    v_xor_b32 v22, 64, v20
    v_xor_b32 v23, 96, v20
    v_xor_b32 v121, 32, v120
    v_xor_b32 v122, 64, v120
    v_xor_b32 v123, 96, v120
    v_xor_b32 v124, 128, v120
    v_xor_b32 v125, 160, v120
    v_xor_b32 v126, 192, v120
    v_xor_b32 v127, 224, v120
    v_and_b32 v13, 31, v1
    v_lshlrev_b32 v13, 5, v13
    v_add_u32 v13, 131072, v13
    s_lshl_b32 s68, s44, 3
    v_lshl_add_u32 v14, v12, 2, v13
    v_add_u32 v14, s68, v14
    s_lshl_b32 s68, s44, 13
    s_add_u32 s68, s68, 131072
    v_add_u32 v15, s68, v9
    s_waitcnt lgkmcnt(0)
    s_add_u32 s42, s42, 1
    s_mul_i32 s43, s42, 0x9E3779B1
    s_xor_b32 s43, s43, 0x5BD1E995
    s_lshl_b32 s72, s45, 14
    s_add_u32 s72, s72, 1048576
    s_lshl_b32 s73, s46, 10
    s_add_u32 s73, s73, s72
    s_lshl_b32 s68, s44, 7
    s_add_u32 s69, s72, s68
    s_lshl_b32 s68, s46, 5
    s_add_u32 s72, s72, s68
    s_lshl_b32 s74, s70, 15
    s_lshl_b32 s68, s44, 9
    s_add_u32 s74, s74, s68
    s_add_u32 s74, s74, 4194304
    s_add_u32 s75, s74, 8192
    s_add_u32 s78, s74, 16384
    s_add_u32 s79, s74, 24576
    s_lshl_b32 s70, s46, 15
    s_lshl_b32 s71, s45, 11
    s_add_u32 s70, s70, s71
    s_add_u32 s70, s70, 1310720
    s_lshl_b32 s71, s44, 8
    s_add_u32 s71, s71, s70
    v_and_b32 v100, 15, v1
    v_and_b32 v101, 1, v4
    v_lshlrev_b32 v112, 10, v100
    v_lshl_add_u32 v102, v101, 4, v112
    v_lshlrev_b32 v103, 11, v4
    v_lshl_add_u32 v103, v100, 4, v103
    v_and_b32 v104, 1, v3
    v_lshlrev_b32 v104, 4, v104
    v_mov_b32 v105, 0xffff
    v_lshlrev_b32 v105, v104, v105
    v_lshrrev_b32 v104, 1, v3
    v_cmp_eq_u32 vcc, 0, v104
    s_nop 1
    v_cndmask_b32 v108, 0, v105, vcc
    v_cmp_eq_u32 vcc, 1, v104
    s_nop 1
    v_cndmask_b32 v109, 0, v105, vcc
    v_cmp_eq_u32 vcc, 2, v104
    s_nop 1
    v_cndmask_b32 v110, 0, v105, vcc
    v_cmp_eq_u32 vcc, 3, v104
    s_nop 1
    v_cndmask_b32 v111, 0, v105, vcc
    v_lshrrev_b32 v104, 2, v3
    v_lshl_add_u32 v105, v104, 4, v4
    v_lshlrev_b32 v105, 2, v105
    v_lshlrev_b32 v106, 14, v104
    v_lshl_add_u32 v106, v6, 5, v106
    v_lshl_add_u32 v106, v4, 3, v106
    v_and_b32 v104, 1, v2
    v_lshl_add_u32 v106, v104, 7, v106
    v_lshlrev_b32 v107, 14, v101
    v_lshl_add_u32 v107, v100, 3, v107
    v_mov_b32 v113, 149504
    s_waitcnt vmcnt(0)
    ds_read_b128 v[128:131], v120 offset:0
    ds_read_b128 v[132:135], v121 offset:0
    ds_read_b128 v[136:139], v122 offset:0
    ds_read_b128 v[140:143], v123 offset:0
    ds_read_b128 v[144:147], v124 offset:0
    ds_read_b128 v[148:151], v125 offset:0
    ds_read_b128 v[152:155], v126 offset:0
    ds_read_b128 v[156:159], v127 offset:0
    ds_read_b128 v[160:163], v120 offset:256
    ds_read_b128 v[164:167], v121 offset:256
    ds_read_b128 v[168:171], v122 offset:256
    ds_read_b128 v[172:175], v123 offset:256
    s_waitcnt lgkmcnt(8)
    ds_read_b128 v[176:179], v124 offset:256
    ds_read_b128 v[180:183], v125 offset:256
    ds_read_b128 v[184:187], v126 offset:256
    ds_read_b128 v[188:191], v127 offset:256
    s_waitcnt lgkmcnt(8)
    ds_read_b128 v[192:195], v120 offset:512
    ds_read_b128 v[196:199], v121 offset:512
    ds_read_b128 v[200:203], v122 offset:512
    ds_read_b128 v[204:207], v123 offset:512
    s_waitcnt lgkmcnt(8)
    ds_read_b128 v[208:211], v124 offset:512
    ds_read_b128 v[212:215], v125 offset:512
    ds_read_b128 v[216:219], v126 offset:512
    ds_read_b128 v[220:223], v127 offset:512
    s_waitcnt lgkmcnt(8)
    ds_read_b128 v[224:227], v120 offset:768
    ds_read_b128 v[228:231], v121 offset:768
    ds_read_b128 v[232:235], v122 offset:768
    ds_read_b128 v[236:239], v123 offset:768
    s_waitcnt lgkmcnt(8)
    ds_read_b128 v[240:243], v124 offset:768
    ds_read_b128 v[244:247], v125 offset:768
    ds_read_b128 v[248:251], v126 offset:768
    ds_read_b128 v[252:255], v127 offset:768
    s_waitcnt lgkmcnt(0)
    s_setprio 2
    s_barrier
    ds_read_b128 v[64:67], v20 offset:0
    ds_read_b128 v[68:71], v21 offset:0
    ds_read_b128 v[72:75], v22 offset:0
    ds_read_b128 v[76:79], v23 offset:0
    ds_read_b128 v[80:83], v20 offset:1024
    ds_read_b128 v[84:87], v21 offset:1024
    ds_read_b128 v[88:91], v22 offset:1024
    ds_read_b128 v[92:95], v23 offset:1024
    s_waitcnt lgkmcnt(7)
    v_mfma_f32_32x32x16_bf16 v[32:47], v[128:131], v[64:67], 0
    ds_read_b128 v[64:67], v20 offset:2048
    s_waitcnt lgkmcnt(7)
    v_mfma_f32_32x32x16_bf16 v[32:47], v[132:135], v[68:71], v[32:47]
    ds_read_b128 v[68:71], v21 offset:2048
    s_waitcnt lgkmcnt(7)
    v_mfma_f32_32x32x16_bf16 v[32:47], v[136:139], v[72:75], v[32:47]
    ds_read_b128 v[72:75], v22 offset:2048
    s_waitcnt lgkmcnt(7)
    v_mfma_f32_32x32x16_bf16 v[32:47], v[140:143], v[76:79], v[32:47]
    ds_read_b128 v[76:79], v23 offset:2048
    buffer_load_dwordx4 v[116:119], v103, s[48:51], s74 offen offset:0
    s_waitcnt lgkmcnt(7)
    v_mfma_f32_32x32x16_bf16 v[32:47], v[144:147], v[80:83], v[32:47]
    ds_read_b128 v[80:83], v20 offset:3072
    s_waitcnt lgkmcnt(7)
    v_mfma_f32_32x32x16_bf16 v[32:47], v[148:151], v[84:87], v[32:47]
    ds_read_b128 v[84:87], v21 offset:3072
    s_waitcnt lgkmcnt(7)
    v_mfma_f32_32x32x16_bf16 v[32:47], v[152:155], v[88:91], v[32:47]
    ds_read_b128 v[88:91], v22 offset:3072
    s_waitcnt lgkmcnt(7)
    v_mfma_f32_32x32x16_bf16 v[32:47], v[156:159], v[92:95], v[32:47]
    ds_read_b128 v[92:95], v23 offset:3072
    buffer_load_dwordx4 v[116:119], v103, s[48:51], s74 offen offset:256
    s_waitcnt lgkmcnt(7)
    v_mfma_f32_32x32x16_bf16 v[32:47], v[160:163], v[64:67], v[32:47]
    ds_read_b128 v[64:67], v20 offset:4096
    s_waitcnt lgkmcnt(7)
    v_mfma_f32_32x32x16_bf16 v[32:47], v[164:167], v[68:71], v[32:47]
    ds_read_b128 v[68:71], v21 offset:4096
    s_waitcnt lgkmcnt(7)
    v_mfma_f32_32x32x16_bf16 v[32:47], v[168:171], v[72:75], v[32:47]
    ds_read_b128 v[72:75], v22 offset:4096
    s_waitcnt lgkmcnt(7)
    v_mfma_f32_32x32x16_bf16 v[32:47], v[172:175], v[76:79], v[32:47]
    ds_read_b128 v[76:79], v23 offset:4096
    buffer_load_dwordx4 v[116:119], v103, s[48:51], s75 offen offset:0
    s_waitcnt lgkmcnt(7)
    v_mfma_f32_32x32x16_bf16 v[32:47], v[176:179], v[80:83], v[32:47]
    ds_read_b128 v[80:83], v20 offset:5120
    s_waitcnt lgkmcnt(7)
    v_mfma_f32_32x32x16_bf16 v[32:47], v[180:183], v[84:87], v[32:47]
    ds_read_b128 v[84:87], v21 offset:5120
    s_barrier
    s_waitcnt lgkmcnt(7)
    v_mfma_f32_32x32x16_bf16 v[32:47], v[184:187], v[88:91], v[32:47]
    ds_read_b128 v[88:91], v22 offset:5120
    s_waitcnt lgkmcnt(7)
    v_mfma_f32_32x32x16_bf16 v[32:47], v[188:191], v[92:95], v[32:47]
    ds_read_b128 v[92:95], v23 offset:5120
    buffer_load_dwordx4 v[116:119], v103, s[48:51], s75 offen offset:256
    s_waitcnt lgkmcnt(7)
    v_mfma_f32_32x32x16_bf16 v[32:47], v[192:195], v[64:67], v[32:47]
    ds_read_b128 v[64:67], v20 offset:6144
    s_waitcnt lgkmcnt(7)
    v_mfma_f32_32x32x16_bf16 v[32:47], v[196:199], v[68:71], v[32:47]
    ds_read_b128 v[68:71], v21 offset:6144
    s_waitcnt lgkmcnt(7)
    v_mfma_f32_32x32x16_bf16 v[32:47], v[200:203], v[72:75], v[32:47]
    ds_read_b128 v[72:75], v22 offset:6144
    s_waitcnt lgkmcnt(7)
    v_mfma_f32_32x32x16_bf16 v[32:47], v[204:207], v[76:79], v[32:47]
    ds_read_b128 v[76:79], v23 offset:6144
    buffer_load_dwordx4 v[116:119], v103, s[48:51], s78 offen offset:0
    s_waitcnt lgkmcnt(7)
    v_mfma_f32_32x32x16_bf16 v[32:47], v[208:211], v[80:83], v[32:47]
    ds_read_b128 v[80:83], v20 offset:7168
    s_waitcnt lgkmcnt(7)
    v_mfma_f32_32x32x16_bf16 v[32:47], v[212:215], v[84:87], v[32:47]
    ds_read_b128 v[84:87], v21 offset:7168
    s_waitcnt lgkmcnt(7)
    v_mfma_f32_32x32x16_bf16 v[32:47], v[216:219], v[88:91], v[32:47]
    ds_read_b128 v[88:91], v22 offset:7168
    s_waitcnt lgkmcnt(7)
    v_mfma_f32_32x32x16_bf16 v[32:47], v[220:223], v[92:95], v[32:47]
    ds_read_b128 v[92:95], v23 offset:7168
    buffer_load_dwordx4 v[116:119], v103, s[48:51], s78 offen offset:256
    s_waitcnt lgkmcnt(7)
    v_mfma_f32_32x32x16_bf16 v[32:47], v[224:227], v[64:67], v[32:47]
    s_waitcnt lgkmcnt(6)
    v_mfma_f32_32x32x16_bf16 v[32:47], v[228:231], v[68:71], v[32:47]
    s_waitcnt lgkmcnt(5)
    v_mfma_f32_32x32x16_bf16 v[32:47], v[232:235], v[72:75], v[32:47]
    s_waitcnt lgkmcnt(4)
    v_mfma_f32_32x32x16_bf16 v[32:47], v[236:239], v[76:79], v[32:47]
    buffer_load_dwordx4 v[116:119], v103, s[48:51], s79 offen offset:0
    s_waitcnt lgkmcnt(3)
    v_mfma_f32_32x32x16_bf16 v[32:47], v[240:243], v[80:83], v[32:47]
    s_waitcnt lgkmcnt(2)
    v_mfma_f32_32x32x16_bf16 v[32:47], v[244:247], v[84:87], v[32:47]
    s_waitcnt lgkmcnt(1)
    v_mfma_f32_32x32x16_bf16 v[32:47], v[248:251], v[88:91], v[32:47]
    s_waitcnt lgkmcnt(0)
    v_mfma_f32_32x32x16_bf16 v[32:47], v[252:255], v[92:95], v[32:47]
    buffer_load_dwordx4 v[116:119], v103, s[48:51], s79 offen offset:256
    s_nop 10
    v_max3_f32 v24, v32, v33, v34
    v_max3_f32 v25, v35, v36, v37
    v_max3_f32 v26, v38, v39, v40
    v_max3_f32 v27, v41, v42, v43
    v_max3_f32 v28, v44, v45, v46
    v_max3_f32 v24, v24, v25, v26
    v_max3_f32 v27, v27, v28, v47
    v_max_f32 v24, v24, v27
    ds_write_b32 v14, v24 offset:2048
    s_waitcnt lgkmcnt(0)
    s_barrier
    ds_read_b128 v[24:27], v13 offset:2048
    ds_read_b128 v[28:31], v13 offset:2064
    s_waitcnt lgkmcnt(0)
    v_max3_f32 v24, v24, v25, v26
    v_max3_f32 v28, v28, v29, v30
    v_max3_f32 v24, v24, v27, v31
    v_max_f32 v24, v24, v28
    v_sub_f32 v32, v32, v24
    v_sub_f32 v33, v33, v24
    v_sub_f32 v34, v34, v24
    v_sub_f32 v35, v35, v24
    v_sub_f32 v36, v36, v24
    v_sub_f32 v37, v37, v24
    v_sub_f32 v38, v38, v24
    v_sub_f32 v39, v39, v24
    v_exp_f32 v32, v32
    v_exp_f32 v33, v33
    v_exp_f32 v34, v34
    v_exp_f32 v35, v35
    v_exp_f32 v36, v36
    v_exp_f32 v37, v37
    v_exp_f32 v38, v38
    v_exp_f32 v39, v39
    v_cvt_pk_bf16_f32 v48, v32, v33
    v_cvt_pk_bf16_f32 v49, v34, v35
    v_cvt_pk_bf16_f32 v50, v36, v37
    v_cvt_pk_bf16_f32 v51, v38, v39
    ds_write_b128 v15, v[48:51] offset:0
    s_waitcnt lgkmcnt(0)
    s_barrier
    v_sub_f32 v40, v40, v24
    v_sub_f32 v41, v41, v24
    v_sub_f32 v42, v42, v24
    v_sub_f32 v43, v43, v24
    v_sub_f32 v44, v44, v24
    v_sub_f32 v45, v45, v24
    v_sub_f32 v46, v46, v24
    v_sub_f32 v47, v47, v24
    v_exp_f32 v40, v40
    v_exp_f32 v41, v41
    v_exp_f32 v42, v42
    v_exp_f32 v43, v43
    v_exp_f32 v44, v44
    v_exp_f32 v45, v45
    v_exp_f32 v46, v46
    v_exp_f32 v47, v47
    v_cvt_pk_bf16_f32 v52, v40, v41
    v_cvt_pk_bf16_f32 v53, v42, v43
    v_cvt_pk_bf16_f32 v54, v44, v45
    v_cvt_pk_bf16_f32 v55, v46, v47
    ds_write_b128 v15, v[52:55] offset:1024
    v_add_f32 v32, v32, v40
    v_add_f32 v33, v33, v41
    v_add_f32 v34, v34, v42
    v_add_f32 v35, v35, v43
    v_add_f32 v36, v36, v44
    v_add_f32 v37, v37, v45
    v_add_f32 v38, v38, v46
    v_add_f32 v39, v39, v47
    v_add_f32 v32, v32, v36
    v_add_f32 v33, v33, v37
    v_add_f32 v34, v34, v38
    v_add_f32 v35, v35, v39
    v_add_f32 v32, v32, v34
    v_add_f32 v33, v33, v35
    v_add_f32 v32, v32, v33
    ds_write_b32 v14, v32 offset:10240
    s_waitcnt lgkmcnt(0)
    s_setprio 0
    s_barrier
    s_cmp_lg_u32 s44, 0
    s_cbranch_scc1 L_nost
    ds_read_b128 v[28:31], v13 offset:10240
    ds_read_b128 v[32:35], v13 offset:10256
    ds_read_b32 v36, v113
    v_mov_b32 v25, s43
    v_mov_b32 v27, s43
    s_waitcnt lgkmcnt(0)
    v_add_f32 v28, v28, v29
    v_add_f32 v30, v30, v31
    v_add_f32 v32, v32, v33
    v_add_f32 v34, v34, v35
    v_readfirstlane_b32 s64, v36
    v_add_f32 v28, v28, v30
    v_add_f32 v32, v32, v34
    v_add_f32 v26, v28, v32
    s_mov_b32 exec_hi, 0
    s_cmp_lg_u32 s64, 0
    s_cbranch_scc1 L_stfar
    buffer_store_dwordx4 v[24:27], v9, s[48:51], s73 offen
    s_branch L_stdone
L_stfar:
    buffer_store_dwordx4 v[24:27], v9, s[48:51], s73 offen sc1
L_stdone:
    s_mov_b64 exec, -1
L_nost:
    s_mov_b32 s77, 0
    s_mov_b32 exec_hi, 0
L_rpoll:
    buffer_load_dwordx4 v[32:35], v102, s[48:51], s72 offen sc1
    s_add_u32 s77, s77, 1
    s_waitcnt vmcnt(0)
    v_xor_b32 v33, s43, v33
    v_xor_b32 v35, s43, v35
    v_or_b32 v33, v33, v35
    v_cmp_ne_u32 vcc, 0, v33
    s_cmp_ge_u32 s77, 400000
    s_cbranch_scc1 L_rdone
    s_cbranch_vccnz L_rpoll
L_rdone:
    s_mov_b64 exec, -1
    v_mov_b32 v36, v32
    s_nop 1
    v_max_f32_dpp v36, v36, v36 row_ror:8 row_mask:0xf bank_mask:0xf
    s_nop 1
    v_max_f32_dpp v36, v36, v36 row_ror:4 row_mask:0xf bank_mask:0xf
    s_nop 1
    v_max_f32_dpp v36, v36, v36 row_ror:2 row_mask:0xf bank_mask:0xf
    s_nop 1
    v_max_f32_dpp v36, v36, v36 row_ror:1 row_mask:0xf bank_mask:0xf
    v_sub_f32 v33, v32, v36
    v_exp_f32 v33, v33
    s_nop 0
    v_mul_f32 v37, v33, v34
    ds_bpermute_b32 v40, v105, v33 offset:0
    ds_bpermute_b32 v41, v105, v33 offset:16
    ds_bpermute_b32 v42, v105, v33 offset:32
    ds_bpermute_b32 v43, v105, v33 offset:48
    v_add_f32_dpp v37, v37, v37 row_ror:8 row_mask:0xf bank_mask:0xf
    s_nop 1
    v_add_f32_dpp v37, v37, v37 row_ror:4 row_mask:0xf bank_mask:0xf
    s_nop 1
    v_add_f32_dpp v37, v37, v37 row_ror:2 row_mask:0xf bank_mask:0xf
    s_nop 1
    v_add_f32_dpp v37, v37, v37 row_ror:1 row_mask:0xf bank_mask:0xf
    v_cmp_gt_u32 s[66:67], 8, v100
    s_waitcnt lgkmcnt(0)
    v_cvt_pk_bf16_f32 v44, v40, v40
    v_cvt_pk_bf16_f32 v45, v41, v41
    v_cvt_pk_bf16_f32 v46, v42, v42
    v_cvt_pk_bf16_f32 v47, v43, v43
    v_and_b32 v80, 0xffff0000, v44
    v_and_b32 v81, 0xffff0000, v45
    v_and_b32 v82, 0xffff0000, v46
    v_and_b32 v83, 0xffff0000, v47
    v_sub_f32 v80, v40, v80
    v_sub_f32 v81, v41, v81
    v_sub_f32 v82, v42, v82
    v_sub_f32 v83, v43, v83
    v_cvt_pk_bf16_f32 v80, v80, v80
    v_cvt_pk_bf16_f32 v81, v81, v81
    v_cvt_pk_bf16_f32 v82, v82, v82
    v_cvt_pk_bf16_f32 v83, v83, v83
    v_cndmask_b32 v44, v80, v44, s[66:67]
    v_cndmask_b32 v45, v81, v45, s[66:67]
    v_cndmask_b32 v46, v82, v46, s[66:67]
    v_cndmask_b32 v47, v83, v47, s[66:67]
    v_and_b32 v64, v44, v108
    v_and_b32 v65, v44, v109
    v_and_b32 v66, v44, v110
    v_and_b32 v67, v44, v111
    v_and_b32 v68, v45, v108
    v_and_b32 v69, v45, v109
    v_and_b32 v70, v45, v110
    v_and_b32 v71, v45, v111
    v_and_b32 v72, v46, v108
    v_and_b32 v73, v46, v109
    v_and_b32 v74, v46, v110
    v_and_b32 v75, v46, v111
    v_and_b32 v76, v47, v108
    v_and_b32 v77, v47, v109
    v_and_b32 v78, v47, v110
    v_and_b32 v79, v47, v111
    s_mov_b32 s77, 0
    s_mov_b64 exec, 0xffff
L_fpoll:
    buffer_load_dword v32, v112, s[48:51], s69 offen offset:512 sc1
    s_add_u32 s77, s77, 1
    s_waitcnt vmcnt(0)
    v_cmp_ne_u32 vcc, s43, v32
    s_cmp_ge_u32 s77, 400000
    s_cbranch_scc1 L_fdone
    s_cbranch_vccnz L_fpoll
L_fdone:
    s_mov_b64 exec, -1
    buffer_load_dwordx4 v[144:147], v103, s[48:51], s74 offen offset:0 sc1
    buffer_load_dwordx4 v[148:151], v103, s[48:51], s74 offen offset:256 sc1
    buffer_load_dwordx4 v[152:155], v103, s[48:51], s75 offen offset:0 sc1
    buffer_load_dwordx4 v[156:159], v103, s[48:51], s75 offen offset:256 sc1
    buffer_load_dwordx4 v[160:163], v103, s[48:51], s78 offen offset:0 sc1
    buffer_load_dwordx4 v[164:167], v103, s[48:51], s78 offen offset:256 sc1
    buffer_load_dwordx4 v[168:171], v103, s[48:51], s79 offen offset:0 sc1
    buffer_load_dwordx4 v[172:175], v103, s[48:51], s79 offen offset:256 sc1
    s_waitcnt vmcnt(7)
    v_mfma_f32_16x16x32_bf16 v[40:43], v[144:147], v[64:67], 0
    s_waitcnt vmcnt(6)
    v_mfma_f32_16x16x32_bf16 v[44:47], v[148:151], v[64:67], 0
    s_waitcnt vmcnt(5)
    v_mfma_f32_16x16x32_bf16 v[40:43], v[152:155], v[68:71], v[40:43]
    s_waitcnt vmcnt(4)
    v_mfma_f32_16x16x32_bf16 v[44:47], v[156:159], v[68:71], v[44:47]
    s_waitcnt vmcnt(3)
    v_mfma_f32_16x16x32_bf16 v[40:43], v[160:163], v[72:75], v[40:43]
    s_waitcnt vmcnt(2)
    v_mfma_f32_16x16x32_bf16 v[44:47], v[164:167], v[72:75], v[44:47]
    s_waitcnt vmcnt(1)
    v_mfma_f32_16x16x32_bf16 v[40:43], v[168:171], v[76:79], v[40:43]
    s_waitcnt vmcnt(0)
    v_mfma_f32_16x16x32_bf16 v[44:47], v[172:175], v[76:79], v[44:47]
    s_cmp_lg_u32 s44, 1
    s_cbranch_scc1 L_rnostat
    s_mov_b32 exec_hi, 0
    buffer_store_dwordx2 v[36:37], v107, s[48:51], s70 offen offset:1024 sc1
    s_mov_b64 exec, -1
L_rnostat:
    s_nop 5
    v_cndmask_b32 v48, v40, v44, s[66:67]
    v_cndmask_b32 v49, v41, v45, s[66:67]
    v_cndmask_b32 v50, v42, v46, s[66:67]
    v_cndmask_b32 v51, v43, v47, s[66:67]
    v_cndmask_b32 v40, v44, v40, s[66:67]
    v_cndmask_b32 v41, v45, v41, s[66:67]
    v_cndmask_b32 v42, v46, v42, s[66:67]
    v_cndmask_b32 v43, v47, v43, s[66:67]
    v_add_f32_dpp v40, v48, v40 row_ror:8 row_mask:0xf bank_mask:0xf
    v_add_f32_dpp v41, v49, v41 row_ror:8 row_mask:0xf bank_mask:0xf
    v_add_f32_dpp v42, v50, v42 row_ror:8 row_mask:0xf bank_mask:0xf
    v_add_f32_dpp v43, v51, v43 row_ror:8 row_mask:0xf bank_mask:0xf
    v_cvt_pk_bf16_f32 v44, v40, v41
    v_cvt_pk_bf16_f32 v45, v42, v43
    buffer_store_dwordx2 v[44:45], v106, s[48:51], s71 offen sc1
    s_branch L_end
L_att_hi:
    s_load_dwordx2 s[48:49], s[0:1], 96
    s_load_dwordx16 s[16:31], s[0:1], 0
    s_load_dwordx8 s[32:39], s[0:1], 64
    s_mov_b32 s50, 0x10000000
    s_mov_b32 s51, 0x20000
    s_mov_b32 s55, 0x20000
    v_lshrrev_b32 v2, 3, v1
    v_and_b32 v3, 7, v1
    v_lshrrev_b32 v4, 4, v1
    v_bfe_u32 v5, v1, 2, 2
    v_and_b32 v6, 3, v1
    v_lshlrev_b32 v7, 4, v0
    v_mov_b32 v8, 0
    s_load_dwordx2 s[56:57], s[0:1], 16
    s_mov_b32 s58, 4718592
    s_mov_b32 s59, 0x20000
    s_setprio 2
    s_sub_u32 s66, s44, 4
    s_lshl_b32 s67, s45, 15
    s_lshl_b32 s68, s46, 11
    s_add_u32 s68, s68, s67
    s_add_u32 s69, s68, 786432
    s_waitcnt lgkmcnt(0)
    s_load_dword s42, s[48:49], 0
    s_cmp_lg_u32 s66, 1
    s_cbranch_scc1 L_h_b
    buffer_load_dwordx4 v[248:251], v9, s[48:51], s69 offen
    buffer_load_dwordx4 v[248:251], v9, s[48:51], s69 offen offset:1024
L_h_b:
    s_cmp_lt_u32 s66, 2
    s_cbranch_scc1 L_h_c
    s_lshr_b32 s68, s46, 2
    s_mul_i32 s68, s68, 144
    s_and_b32 s69, s46, 3
    s_lshl_b32 s69, s69, 2
    s_add_u32 s68, s68, s69
    s_lshl_b32 s69, s66, 1
    s_add_u32 s68, s68, s69
    s_add_u32 s68, s68, 124
    s_lshl_b32 s68, s68, 13
    s_lshl_b32 s69, s45, 10
    s_add_u32 s68, s68, s69
    s_add_u32 s69, s68, 8192
    buffer_load_dwordx4 v[248:251], v9, s[56:59], s68 offen
    buffer_load_dwordx4 v[248:251], v9, s[56:59], s69 offen
L_h_c:
    s_lshr_b32 s67, s45, 1
    s_lshl_b32 s67, s67, 15
    s_lshl_b32 s68, s66, 13
    s_add_u32 s67, s67, s68
    s_add_u32 s67, s67, 524288
    s_and_b32 s69, s66, 1
    s_lshl_b32 s69, s69, 1
    v_xor_b32 v10, s69, v3
    v_lshlrev_b32 v10, 4, v10
    v_lshl_add_u32 v10, v2, 10, v10
    s_add_u32 s68, s68, 131072
    v_add_u32 v16, s68, v10
    v_xor_b32 v17, 64, v16
    v_xor_b32 v18, 16, v16
    v_xor_b32 v19, 80, v16
    v_lshrrev_b32 v12, 5, v1
    v_and_b32 v13, 1, v4
    v_lshrrev_b32 v14, 1, v6
    v_lshl_or_b32 v13, v13, 1, v14
    v_lshl_or_b32 v14, v5, 2, v12
    v_xor_b32 v13, v13, v14
    v_lshlrev_b32 v13, 4, v13
    v_lshl_add_u32 v13, v5, 10, v13
    v_lshl_add_u32 v13, v12, 12, v13
    v_and_b32 v14, 1, v6
    v_lshl_add_u32 v13, v14, 3, v13
    s_lshl_b32 s68, s66, 8
    v_add_u32 v20, s68, v13
    v_xor_b32 v21, 32, v20
    v_xor_b32 v22, 64, v20
    v_xor_b32 v23, 96, v20
    v_xor_b32 v24, 128, v20
    v_xor_b32 v25, 160, v20
    v_xor_b32 v26, 192, v20
    v_xor_b32 v27, 224, v20
    s_getreg_b32 s65, hwreg(HW_REG_XCC_ID, 0, 4)
    s_lshl_b32 s72, s45, 11
    s_add_u32 s72, s72, 196608
    s_waitcnt lgkmcnt(0)
    s_add_u32 s42, s42, 1
    s_mul_i32 s43, s42, 0x9E3779B1
    s_xor_b32 s43, s43, 0x5BD1E995
    s_cmp_lg_u32 s66, 0
    s_cbranch_scc1 L_noxt
    s_lshl_b32 s68, s46, 7
    s_add_u32 s68, s68, s72
    v_mov_b32 v28, s65
    v_mov_b32 v29, s43
    v_lshlrev_b32 v30, 3, v1
    s_mov_b64 exec, 0xffff
    buffer_store_dwordx2 v[28:29], v30, s[48:51], s68 offen sc1
    s_mov_b64 exec, -1
L_noxt:
    s_add_u32 s72, s48, s72
    s_addc_u32 s73, s49, 0
    s_and_b32 s74, s2, 15
    s_lshl_b32 s74, s74, 10
    s_lshl_b32 s75, s66, 8
    s_add_u32 s74, s74, s75
    s_add_u32 s74, s74, 655360
    s_add_u32 s74, s48, s74
    s_addc_u32 s75, s49, 0
    s_mov_b32 s77, 0
    s_cmp_lg_u32 s66, 0
    s_cbranch_scc1 L_nx
L_nxp:
    s_mov_b32 s64, 0
    s_mov_b32 s76, 0
    s_load_dwordx2 s[16:17], s[72:73], 0 glc
    s_load_dwordx2 s[18:19], s[72:73], 128 glc
    s_load_dwordx2 s[20:21], s[72:73], 256 glc
    s_load_dwordx2 s[22:23], s[72:73], 384 glc
    s_load_dwordx2 s[24:25], s[72:73], 512 glc
    s_load_dwordx2 s[26:27], s[72:73], 640 glc
    s_load_dwordx2 s[28:29], s[72:73], 768 glc
    s_load_dwordx2 s[30:31], s[72:73], 896 glc
    s_load_dwordx2 s[32:33], s[72:73], 1024 glc
    s_load_dwordx2 s[34:35], s[72:73], 1152 glc
    s_load_dwordx2 s[36:37], s[72:73], 1280 glc
    s_load_dwordx2 s[38:39], s[72:73], 1408 glc
    s_load_dwordx2 s[52:53], s[72:73], 1536 glc
    s_load_dwordx2 s[54:55], s[72:73], 1664 glc
    s_load_dwordx2 s[56:57], s[72:73], 1792 glc
    s_load_dwordx2 s[58:59], s[72:73], 1920 glc
    s_waitcnt lgkmcnt(0)
    s_xor_b32 s16, s16, s65
    s_or_b32 s64, s64, s16
    s_xor_b32 s17, s17, s43
    s_or_b32 s76, s76, s17
    s_xor_b32 s18, s18, s65
    s_or_b32 s64, s64, s18
    s_xor_b32 s19, s19, s43
    s_or_b32 s76, s76, s19
    s_xor_b32 s20, s20, s65
    s_or_b32 s64, s64, s20
    s_xor_b32 s21, s21, s43
    s_or_b32 s76, s76, s21
    s_xor_b32 s22, s22, s65
    s_or_b32 s64, s64, s22
    s_xor_b32 s23, s23, s43
    s_or_b32 s76, s76, s23
    s_xor_b32 s24, s24, s65
    s_or_b32 s64, s64, s24
    s_xor_b32 s25, s25, s43
    s_or_b32 s76, s76, s25
    s_xor_b32 s26, s26, s65
    s_or_b32 s64, s64, s26
    s_xor_b32 s27, s27, s43
    s_or_b32 s76, s76, s27
    s_xor_b32 s28, s28, s65
    s_or_b32 s64, s64, s28
    s_xor_b32 s29, s29, s43
    s_or_b32 s76, s76, s29
    s_xor_b32 s30, s30, s65
    s_or_b32 s64, s64, s30
    s_xor_b32 s31, s31, s43
    s_or_b32 s76, s76, s31
    s_xor_b32 s32, s32, s65
    s_or_b32 s64, s64, s32
    s_xor_b32 s33, s33, s43
    s_or_b32 s76, s76, s33
    s_xor_b32 s34, s34, s65
    s_or_b32 s64, s64, s34
    s_xor_b32 s35, s35, s43
    s_or_b32 s76, s76, s35
    s_xor_b32 s36, s36, s65
    s_or_b32 s64, s64, s36
    s_xor_b32 s37, s37, s43
    s_or_b32 s76, s76, s37
    s_xor_b32 s38, s38, s65
    s_or_b32 s64, s64, s38
    s_xor_b32 s39, s39, s43
    s_or_b32 s76, s76, s39
    s_xor_b32 s52, s52, s65
    s_or_b32 s64, s64, s52
    s_xor_b32 s53, s53, s43
    s_or_b32 s76, s76, s53
    s_xor_b32 s54, s54, s65
    s_or_b32 s64, s64, s54
    s_xor_b32 s55, s55, s43
    s_or_b32 s76, s76, s55
    s_xor_b32 s56, s56, s65
    s_or_b32 s64, s64, s56
    s_xor_b32 s57, s57, s43
    s_or_b32 s76, s76, s57
    s_xor_b32 s58, s58, s65
    s_or_b32 s64, s64, s58
    s_xor_b32 s59, s59, s43
    s_or_b32 s76, s76, s59
    s_or_b32 s64, s64, s76
    s_add_u32 s77, s77, 1
    s_cmp_ge_u32 s77, 12
    s_cbranch_scc1 L_nx
    s_cmp_lg_u32 s76, 0
    s_cbranch_scc1 L_nxp
L_nx:
L_xp:
    s_mov_b32 s76, 0
    s_load_dwordx8 s[16:23], s[74:75], 0 glc
    s_load_dwordx8 s[24:31], s[74:75], 128 glc
    s_waitcnt lgkmcnt(0)
    s_xor_b32 s16, s16, s43
    s_or_b32 s76, s76, s16
    s_xor_b32 s17, s17, s43
    s_or_b32 s76, s76, s17
    s_xor_b32 s18, s18, s43
    s_or_b32 s76, s76, s18
    s_xor_b32 s19, s19, s43
    s_or_b32 s76, s76, s19
    s_xor_b32 s20, s20, s43
    s_or_b32 s76, s76, s20
    s_xor_b32 s21, s21, s43
    s_or_b32 s76, s76, s21
    s_xor_b32 s22, s22, s43
    s_or_b32 s76, s76, s22
    s_xor_b32 s23, s23, s43
    s_or_b32 s76, s76, s23
    s_xor_b32 s24, s24, s43
    s_or_b32 s76, s76, s24
    s_xor_b32 s25, s25, s43
    s_or_b32 s76, s76, s25
    s_xor_b32 s26, s26, s43
    s_or_b32 s76, s76, s26
    s_xor_b32 s27, s27, s43
    s_or_b32 s76, s76, s27
    s_xor_b32 s28, s28, s43
    s_or_b32 s76, s76, s28
    s_xor_b32 s29, s29, s43
    s_or_b32 s76, s76, s29
    s_xor_b32 s30, s30, s43
    s_or_b32 s76, s76, s30
    s_xor_b32 s31, s31, s43
    s_or_b32 s76, s76, s31
    s_add_u32 s77, s77, 1
    s_cmp_ge_u32 s77, 400000
    s_cbranch_scc1 L_xd
    s_cmp_lg_u32 s76, 0
    s_cbranch_scc1 L_xp
L_xd:
    s_barrier
    s_mov_b32 s76, 0xff
    s_mov_b32 s77, 0
    s_add_u32 s69, s67, 4096
L_h2poll:
    s_bitcmp1_b32 s76, 0
    s_cbranch_scc0 L_h2i0
    buffer_load_dwordx4 v[32:35], v9, s[48:51], s67 offen offset:0 sc1
L_h2i0:
    s_bitcmp1_b32 s76, 1
    s_cbranch_scc0 L_h2i1
    buffer_load_dwordx4 v[36:39], v9, s[48:51], s67 offen offset:1024 sc1
L_h2i1:
    s_bitcmp1_b32 s76, 2
    s_cbranch_scc0 L_h2i2
    buffer_load_dwordx4 v[40:43], v9, s[48:51], s67 offen offset:2048 sc1
L_h2i2:
    s_bitcmp1_b32 s76, 3
    s_cbranch_scc0 L_h2i3
    buffer_load_dwordx4 v[44:47], v9, s[48:51], s67 offen offset:3072 sc1
L_h2i3:
    s_bitcmp1_b32 s76, 4
    s_cbranch_scc0 L_h2i4
    buffer_load_dwordx4 v[48:51], v9, s[48:51], s69 offen offset:0 sc1
L_h2i4:
    s_bitcmp1_b32 s76, 5
    s_cbranch_scc0 L_h2i5
    buffer_load_dwordx4 v[52:55], v9, s[48:51], s69 offen offset:1024 sc1
L_h2i5:
    s_bitcmp1_b32 s76, 6
    s_cbranch_scc0 L_h2i6
    buffer_load_dwordx4 v[56:59], v9, s[48:51], s69 offen offset:2048 sc1
L_h2i6:
    s_bitcmp1_b32 s76, 7
    s_cbranch_scc0 L_h2i7
    buffer_load_dwordx4 v[60:63], v9, s[48:51], s69 offen offset:3072 sc1
L_h2i7:
    s_add_u32 s77, s77, 1
    s_cmp_eq_u32 s77, 1
    s_cbranch_scc1 L_h2first
    s_waitcnt vmcnt(0)
L_h2first:
    s_bitcmp1_b32 s76, 0
    s_cbranch_scc0 L_h2c0
    s_waitcnt vmcnt(7)
    v_max3_u32 v28, v32, v33, v34
    v_max_u32 v28, v28, v35
    ds_write_b128 v16, v[32:35] offset:0
    v_cmp_eq_u32 vcc, -1, v28
    s_nop 0
    s_cbranch_vccnz L_h2c0
    s_bitset0_b32 s76, 0
L_h2c0:
    s_bitcmp1_b32 s76, 1
    s_cbranch_scc0 L_h2c1
    s_waitcnt vmcnt(6)
    v_max3_u32 v28, v36, v37, v38
    v_max_u32 v28, v28, v39
    ds_write_b128 v16, v[36:39] offset:128
    v_cmp_eq_u32 vcc, -1, v28
    s_nop 0
    s_cbranch_vccnz L_h2c1
    s_bitset0_b32 s76, 1
L_h2c1:
    s_bitcmp1_b32 s76, 2
    s_cbranch_scc0 L_h2c2
    s_waitcnt vmcnt(5)
    v_max3_u32 v28, v40, v41, v42
    v_max_u32 v28, v28, v43
    ds_write_b128 v17, v[40:43] offset:256
    v_cmp_eq_u32 vcc, -1, v28
    s_nop 0
    s_cbranch_vccnz L_h2c2
    s_bitset0_b32 s76, 2
L_h2c2:
    s_bitcmp1_b32 s76, 3
    s_cbranch_scc0 L_h2c3
    s_waitcnt vmcnt(4)
    v_max3_u32 v28, v44, v45, v46
    v_max_u32 v28, v28, v47
    ds_write_b128 v17, v[44:47] offset:384
    v_cmp_eq_u32 vcc, -1, v28
    s_nop 0
    s_cbranch_vccnz L_h2c3
    s_bitset0_b32 s76, 3
L_h2c3:
    s_bitcmp1_b32 s76, 4
    s_cbranch_scc0 L_h2c4
    s_waitcnt vmcnt(3)
    v_max3_u32 v28, v48, v49, v50
    v_max_u32 v28, v28, v51
    ds_write_b128 v18, v[48:51] offset:512
    v_cmp_eq_u32 vcc, -1, v28
    s_nop 0
    s_cbranch_vccnz L_h2c4
    s_bitset0_b32 s76, 4
L_h2c4:
    s_bitcmp1_b32 s76, 5
    s_cbranch_scc0 L_h2c5
    s_waitcnt vmcnt(2)
    v_max3_u32 v28, v52, v53, v54
    v_max_u32 v28, v28, v55
    ds_write_b128 v18, v[52:55] offset:640
    v_cmp_eq_u32 vcc, -1, v28
    s_nop 0
    s_cbranch_vccnz L_h2c5
    s_bitset0_b32 s76, 5
L_h2c5:
    s_bitcmp1_b32 s76, 6
    s_cbranch_scc0 L_h2c6
    s_waitcnt vmcnt(1)
    v_max3_u32 v28, v56, v57, v58
    v_max_u32 v28, v28, v59
    ds_write_b128 v19, v[56:59] offset:768
    v_cmp_eq_u32 vcc, -1, v28
    s_nop 0
    s_cbranch_vccnz L_h2c6
    s_bitset0_b32 s76, 6
L_h2c6:
    s_bitcmp1_b32 s76, 7
    s_cbranch_scc0 L_h2c7
    s_waitcnt vmcnt(0)
    v_max3_u32 v28, v60, v61, v62
    v_max_u32 v28, v28, v63
    ds_write_b128 v19, v[60:63] offset:896
    v_cmp_eq_u32 vcc, -1, v28
    s_nop 0
    s_cbranch_vccnz L_h2c7
    s_bitset0_b32 s76, 7
L_h2c7:
    s_waitcnt lgkmcnt(0)
    s_cmp_ge_u32 s77, 400000
    s_cbranch_scc1 L_h2done
    s_cmp_eq_u32 s76, 0
    s_cbranch_scc1 L_h2done
    s_branch L_h2poll
L_h2done:
    s_setprio 0
    s_lshl_b32 s70, s45, 4
    s_add_u32 s70, s70, s46
    s_lshl_b32 s76, s70, 15
    s_lshl_b32 s71, s66, 13
    s_add_u32 s76, s76, s71
    s_add_u32 s76, s76, 4194304
    s_add_u32 s78, s76, 4096
    s_lshl_b32 s75, s70, 10
    s_add_u32 s75, s75, 1048576
    s_barrier
    s_cmp_lg_u32 s66, 0
    s_cbranch_scc1 L_npt
    buffer_load_dwordx4 v[248:251], v9, s[48:51], s75 offen
L_npt:
    ds_read_b64_tr_b16 v[96:97], v20 offset:0
    ds_read_b64_tr_b16 v[98:99], v21 offset:8192
    ds_read_b64_tr_b16 v[100:101], v22 offset:0
    ds_read_b64_tr_b16 v[102:103], v23 offset:8192
    ds_read_b64_tr_b16 v[104:105], v24 offset:0
    ds_read_b64_tr_b16 v[106:107], v25 offset:8192
    ds_read_b64_tr_b16 v[108:109], v26 offset:0
    ds_read_b64_tr_b16 v[110:111], v27 offset:8192
    s_barrier
    s_waitcnt lgkmcnt(6)
    ds_read_b64_tr_b16 v[112:113], v20 offset:16384
    ds_read_b64_tr_b16 v[114:115], v21 offset:24576
    ds_read_b64_tr_b16 v[116:117], v22 offset:16384
    ds_read_b64_tr_b16 v[118:119], v23 offset:24576
    ds_read_b64_tr_b16 v[120:121], v24 offset:16384
    ds_read_b64_tr_b16 v[122:123], v25 offset:24576
    ds_read_b64_tr_b16 v[124:125], v26 offset:16384
    ds_read_b64_tr_b16 v[126:127], v27 offset:24576
    s_waitcnt lgkmcnt(6)
    ds_read_b64_tr_b16 v[128:129], v20 offset:32768
    ds_read_b64_tr_b16 v[130:131], v21 offset:40960
    ds_read_b64_tr_b16 v[132:133], v22 offset:32768
    ds_read_b64_tr_b16 v[134:135], v23 offset:40960
    ds_read_b64_tr_b16 v[136:137], v24 offset:32768
    ds_read_b64_tr_b16 v[138:139], v25 offset:40960
    ds_read_b64_tr_b16 v[140:141], v26 offset:32768
    ds_read_b64_tr_b16 v[142:143], v27 offset:40960
    s_waitcnt lgkmcnt(6)
    ds_read_b64_tr_b16 v[144:145], v20 offset:49152
    ds_read_b64_tr_b16 v[146:147], v21 offset:57344
    ds_read_b64_tr_b16 v[148:149], v22 offset:49152
    ds_read_b64_tr_b16 v[150:151], v23 offset:57344
    ds_read_b64_tr_b16 v[152:153], v24 offset:49152
    ds_read_b64_tr_b16 v[154:155], v25 offset:57344
    ds_read_b64_tr_b16 v[156:157], v26 offset:49152
    ds_read_b64_tr_b16 v[158:159], v27 offset:57344
    s_waitcnt lgkmcnt(6)
    v_add_u32 v20, 0x10000, v20
    v_add_u32 v21, 0x10000, v21
    v_add_u32 v22, 0x10000, v22
    v_add_u32 v23, 0x10000, v23
    v_add_u32 v24, 0x10000, v24
    v_add_u32 v25, 0x10000, v25
    v_add_u32 v26, 0x10000, v26
    v_add_u32 v27, 0x10000, v27
    ds_read_b64_tr_b16 v[160:161], v20 offset:0
    ds_read_b64_tr_b16 v[162:163], v21 offset:8192
    ds_read_b64_tr_b16 v[164:165], v22 offset:0
    ds_read_b64_tr_b16 v[166:167], v23 offset:8192
    ds_read_b64_tr_b16 v[168:169], v24 offset:0
    ds_read_b64_tr_b16 v[170:171], v25 offset:8192
    ds_read_b64_tr_b16 v[172:173], v26 offset:0
    ds_read_b64_tr_b16 v[174:175], v27 offset:8192
    s_waitcnt lgkmcnt(6)
    v_mov_b32 v15, 149504
    s_cmp_lg_u32 s66, 0
    s_cbranch_scc1 L_nl
    v_mov_b32 v28, s64
    ds_write_b32 v15, v28
L_nl:
    s_barrier
    ds_read_b64_tr_b16 v[176:177], v20 offset:16384
    ds_read_b64_tr_b16 v[178:179], v21 offset:24576
    ds_read_b64_tr_b16 v[180:181], v22 offset:16384
    ds_read_b64_tr_b16 v[182:183], v23 offset:24576
    ds_read_b64_tr_b16 v[184:185], v24 offset:16384
    ds_read_b64_tr_b16 v[186:187], v25 offset:24576
    ds_read_b64_tr_b16 v[188:189], v26 offset:16384
    ds_read_b64_tr_b16 v[190:191], v27 offset:24576
    s_waitcnt lgkmcnt(6)
    ds_read_b64_tr_b16 v[192:193], v20 offset:32768
    ds_read_b64_tr_b16 v[194:195], v21 offset:40960
    ds_read_b64_tr_b16 v[196:197], v22 offset:32768
    ds_read_b64_tr_b16 v[198:199], v23 offset:40960
    ds_read_b64_tr_b16 v[200:201], v24 offset:32768
    ds_read_b64_tr_b16 v[202:203], v25 offset:40960
    ds_read_b64_tr_b16 v[204:205], v26 offset:32768
    ds_read_b64_tr_b16 v[206:207], v27 offset:40960
    s_waitcnt lgkmcnt(6)
    ds_read_b64_tr_b16 v[208:209], v20 offset:49152
    ds_read_b64_tr_b16 v[210:211], v21 offset:57344
    ds_read_b64_tr_b16 v[212:213], v22 offset:49152
    ds_read_b64_tr_b16 v[214:215], v23 offset:57344
    ds_read_b64_tr_b16 v[216:217], v24 offset:49152
    ds_read_b64_tr_b16 v[218:219], v25 offset:57344
    ds_read_b64_tr_b16 v[220:221], v26 offset:49152
    ds_read_b64_tr_b16 v[222:223], v27 offset:57344
    v_add_u32 v10, 131072, v9
    v_and_b32 v13, 31, v1
    v_lshlrev_b32 v13, 4, v13
    v_lshl_add_u32 v11, v12, 16, v13
    s_lshl_b32 s68, s45, 19
    s_lshl_b32 s69, s46, 11
    s_add_u32 s68, s68, s69
    s_lshl_b32 s70, s66, 9
    s_add_u32 s68, s68, s70
    s_add_u32 s68, s68, 4194304
    s_lshl_b32 s71, s66, 7
    s_add_u32 s71, s71, s75
    v_mov_b32 v14, s43
    s_waitcnt lgkmcnt(0)
    s_setprio 3
    s_barrier
    ds_read_b128 v[224:227], v10 offset:0
    ds_read_b128 v[232:235], v10 offset:8192
    ds_read_b128 v[240:243], v10 offset:16384
    ds_read_b128 v[16:19], v10 offset:24576
    s_waitcnt lgkmcnt(3)
    v_mfma_f32_32x32x16_bf16 v[32:47], v[224:227], v[96:99], 0
    v_mfma_f32_32x32x16_bf16 v[48:63], v[224:227], v[100:103], 0
    v_mfma_f32_32x32x16_bf16 v[64:79], v[224:227], v[104:107], 0
    v_mfma_f32_32x32x16_bf16 v[80:95], v[224:227], v[108:111], 0
    s_waitcnt lgkmcnt(2)
    v_mfma_f32_32x32x16_bf16 v[32:47], v[232:235], v[128:131], v[32:47]
    v_mfma_f32_32x32x16_bf16 v[48:63], v[232:235], v[132:135], v[48:63]
    v_mfma_f32_32x32x16_bf16 v[64:79], v[232:235], v[136:139], v[64:79]
    v_mfma_f32_32x32x16_bf16 v[80:95], v[232:235], v[140:143], v[80:95]
    s_waitcnt lgkmcnt(1)
    v_mfma_f32_32x32x16_bf16 v[32:47], v[240:243], v[160:163], v[32:47]
    v_mfma_f32_32x32x16_bf16 v[48:63], v[240:243], v[164:167], v[48:63]
    v_mfma_f32_32x32x16_bf16 v[64:79], v[240:243], v[168:171], v[64:79]
    v_mfma_f32_32x32x16_bf16 v[80:95], v[240:243], v[172:175], v[80:95]
    s_waitcnt lgkmcnt(0)
    s_barrier
    ds_read_b128 v[228:231], v10 offset:1024
    ds_read_b128 v[236:239], v10 offset:9216
    ds_read_b128 v[244:247], v10 offset:17408
    ds_read_b128 v[252:255], v10 offset:25600
    ds_read_b32 v15, v15
    v_mfma_f32_32x32x16_bf16 v[32:47], v[16:19], v[192:195], v[32:47]
    v_mfma_f32_32x32x16_bf16 v[48:63], v[16:19], v[196:199], v[48:63]
    v_mfma_f32_32x32x16_bf16 v[64:79], v[16:19], v[200:203], v[64:79]
    v_mfma_f32_32x32x16_bf16 v[80:95], v[16:19], v[204:207], v[80:95]
    s_waitcnt lgkmcnt(4)
    v_mfma_f32_32x32x16_bf16 v[32:47], v[228:231], v[112:115], v[32:47]
    v_mfma_f32_32x32x16_bf16 v[48:63], v[228:231], v[116:119], v[48:63]
    v_mfma_f32_32x32x16_bf16 v[64:79], v[228:231], v[120:123], v[64:79]
    v_mfma_f32_32x32x16_bf16 v[80:95], v[228:231], v[124:127], v[80:95]
    s_waitcnt lgkmcnt(3)
    v_mfma_f32_32x32x16_bf16 v[32:47], v[236:239], v[144:147], v[32:47]
    v_mfma_f32_32x32x16_bf16 v[48:63], v[236:239], v[148:151], v[48:63]
    v_mfma_f32_32x32x16_bf16 v[64:79], v[236:239], v[152:155], v[64:79]
    v_mfma_f32_32x32x16_bf16 v[80:95], v[236:239], v[156:159], v[80:95]
    s_waitcnt lgkmcnt(2)
    v_mfma_f32_32x32x16_bf16 v[32:47], v[244:247], v[176:179], v[32:47]
    v_mfma_f32_32x32x16_bf16 v[48:63], v[244:247], v[180:183], v[48:63]
    v_mfma_f32_32x32x16_bf16 v[64:79], v[244:247], v[184:187], v[64:79]
    v_mfma_f32_32x32x16_bf16 v[80:95], v[244:247], v[188:191], v[80:95]
    s_waitcnt lgkmcnt(1)
    v_mfma_f32_32x32x16_bf16 v[32:47], v[252:255], v[208:211], v[32:47]
    v_mfma_f32_32x32x16_bf16 v[48:63], v[252:255], v[212:215], v[48:63]
    v_mfma_f32_32x32x16_bf16 v[64:79], v[252:255], v[216:219], v[64:79]
    v_mfma_f32_32x32x16_bf16 v[80:95], v[252:255], v[220:223], v[80:95]
    s_waitcnt lgkmcnt(0)
    v_readfirstlane_b32 s64, v15
    s_nop 0
    s_cmp_lg_u32 s64, 0
    s_cbranch_scc1 L_pvfar
    s_nop 4
    v_cvt_pk_bf16_f32 v96, v32, v48
    v_cvt_pk_bf16_f32 v98, v33, v49
    s_add_u32 s69, s68, 0
    v_cvt_pk_bf16_f32 v97, v64, v80
    v_cvt_pk_bf16_f32 v99, v65, v81
    buffer_store_dwordx4 v[96:99], v11, s[48:51], s69 offen
    v_cvt_pk_bf16_f32 v100, v34, v50
    v_cvt_pk_bf16_f32 v102, v35, v51
    s_add_u32 s69, s68, 32768
    v_cvt_pk_bf16_f32 v101, v66, v82
    v_cvt_pk_bf16_f32 v103, v67, v83
    buffer_store_dwordx4 v[100:103], v11, s[48:51], s69 offen
    v_cvt_pk_bf16_f32 v104, v36, v52
    v_cvt_pk_bf16_f32 v106, v37, v53
    s_add_u32 s69, s68, 131072
    v_cvt_pk_bf16_f32 v105, v68, v84
    v_cvt_pk_bf16_f32 v107, v69, v85
    buffer_store_dwordx4 v[104:107], v11, s[48:51], s69 offen
    v_cvt_pk_bf16_f32 v108, v38, v54
    v_cvt_pk_bf16_f32 v110, v39, v55
    s_add_u32 s69, s68, 163840
    v_cvt_pk_bf16_f32 v109, v70, v86
    v_cvt_pk_bf16_f32 v111, v71, v87
    buffer_store_dwordx4 v[108:111], v11, s[48:51], s69 offen
    v_cvt_pk_bf16_f32 v112, v40, v56
    v_cvt_pk_bf16_f32 v114, v41, v57
    s_add_u32 s69, s68, 262144
    v_cvt_pk_bf16_f32 v113, v72, v88
    v_cvt_pk_bf16_f32 v115, v73, v89
    buffer_store_dwordx4 v[112:115], v11, s[48:51], s69 offen
    v_cvt_pk_bf16_f32 v116, v42, v58
    v_cvt_pk_bf16_f32 v118, v43, v59
    s_add_u32 s69, s68, 294912
    v_cvt_pk_bf16_f32 v117, v74, v90
    v_cvt_pk_bf16_f32 v119, v75, v91
    buffer_store_dwordx4 v[116:119], v11, s[48:51], s69 offen
    v_cvt_pk_bf16_f32 v120, v44, v60
    v_cvt_pk_bf16_f32 v122, v45, v61
    s_add_u32 s69, s68, 393216
    v_cvt_pk_bf16_f32 v121, v76, v92
    v_cvt_pk_bf16_f32 v123, v77, v93
    buffer_store_dwordx4 v[120:123], v11, s[48:51], s69 offen
    v_cvt_pk_bf16_f32 v124, v46, v62
    v_cvt_pk_bf16_f32 v126, v47, v63
    s_add_u32 s69, s68, 425984
    v_cvt_pk_bf16_f32 v125, v78, v94
    v_cvt_pk_bf16_f32 v127, v79, v95
    buffer_store_dwordx4 v[124:127], v11, s[48:51], s69 offen
    s_mov_b64 exec, 1
    s_waitcnt vmcnt(0)
    buffer_store_dword v14, v8, s[48:51], s71 offen offset:512
    s_mov_b64 exec, -1
L_pvback:
    s_branch L_end
L_pvfar:
    s_nop 9
    v_cvt_pk_bf16_f32 v96, v32, v48
    v_cvt_pk_bf16_f32 v98, v33, v49
    s_add_u32 s69, s68, 0
    v_cvt_pk_bf16_f32 v97, v64, v80
    v_cvt_pk_bf16_f32 v99, v65, v81
    buffer_store_dwordx4 v[96:99], v11, s[48:51], s69 offen sc1
    v_cvt_pk_bf16_f32 v100, v34, v50
    v_cvt_pk_bf16_f32 v102, v35, v51
    s_add_u32 s69, s68, 32768
    v_cvt_pk_bf16_f32 v101, v66, v82
    v_cvt_pk_bf16_f32 v103, v67, v83
    buffer_store_dwordx4 v[100:103], v11, s[48:51], s69 offen sc1
    v_cvt_pk_bf16_f32 v104, v36, v52
    v_cvt_pk_bf16_f32 v106, v37, v53
    s_add_u32 s69, s68, 131072
    v_cvt_pk_bf16_f32 v105, v68, v84
    v_cvt_pk_bf16_f32 v107, v69, v85
    buffer_store_dwordx4 v[104:107], v11, s[48:51], s69 offen sc1
    v_cvt_pk_bf16_f32 v108, v38, v54
    v_cvt_pk_bf16_f32 v110, v39, v55
    s_add_u32 s69, s68, 163840
    v_cvt_pk_bf16_f32 v109, v70, v86
    v_cvt_pk_bf16_f32 v111, v71, v87
    buffer_store_dwordx4 v[108:111], v11, s[48:51], s69 offen sc1
    v_cvt_pk_bf16_f32 v112, v40, v56
    v_cvt_pk_bf16_f32 v114, v41, v57
    s_add_u32 s69, s68, 262144
    v_cvt_pk_bf16_f32 v113, v72, v88
    v_cvt_pk_bf16_f32 v115, v73, v89
    buffer_store_dwordx4 v[112:115], v11, s[48:51], s69 offen sc1
    v_cvt_pk_bf16_f32 v116, v42, v58
    v_cvt_pk_bf16_f32 v118, v43, v59
    s_add_u32 s69, s68, 294912
    v_cvt_pk_bf16_f32 v117, v74, v90
    v_cvt_pk_bf16_f32 v119, v75, v91
    buffer_store_dwordx4 v[116:119], v11, s[48:51], s69 offen sc1
    v_cvt_pk_bf16_f32 v120, v44, v60
    v_cvt_pk_bf16_f32 v122, v45, v61
    s_add_u32 s69, s68, 393216
    v_cvt_pk_bf16_f32 v121, v76, v92
    v_cvt_pk_bf16_f32 v123, v77, v93
    buffer_store_dwordx4 v[120:123], v11, s[48:51], s69 offen sc1
    v_cvt_pk_bf16_f32 v124, v46, v62
    v_cvt_pk_bf16_f32 v126, v47, v63
    s_add_u32 s69, s68, 425984
    v_cvt_pk_bf16_f32 v125, v78, v94
    v_cvt_pk_bf16_f32 v127, v79, v95
    buffer_store_dwordx4 v[124:127], v11, s[48:51], s69 offen sc1
    s_mov_b64 exec, 1
    s_waitcnt vmcnt(0)
    buffer_store_dword v14, v8, s[48:51], s71 offen offset:512 sc1
    s_mov_b64 exec, -1
    s_branch L_pvback
L_end:
L_exit:
    s_endpgm
.section .rodata,"a"
.p2align 6
.amdhsa_kernel recurrent_scan__compressed_kv_cla__glu_gated_geglu__decode_kernel
  .amdhsa_next_free_vgpr 256
  .amdhsa_next_free_sgpr 102
  .amdhsa_accum_offset 256
  .amdhsa_group_segment_fixed_size 0
  .amdhsa_kernarg_size 104
  .amdhsa_user_sgpr_count 2
  .amdhsa_user_sgpr_kernarg_segment_ptr 1
  .amdhsa_system_sgpr_workgroup_id_x 1
  .amdhsa_float_denorm_mode_32 3
.end_amdhsa_kernel
```
